```python
import torch

def _softmax(x, axis=-1):
    return torch.softmax(x, dim=axis)
def _gelu(x):
    return torch.nn.functional.gelu(x, approximate="tanh")
def _silu(x):
    return torch.nn.functional.silu(x)
def _sigmoid(x):
    return torch.sigmoid(x)
def _layernorm(x, axis=-1, eps=1e-5):
    m = x.mean(dim=axis, keepdim=True)
    v = x.var(dim=axis, keepdim=True, unbiased=False)
    return (x - m) / torch.sqrt(v + eps)
def _scatter_add(tgt, idx, src, axis=0):
    return tgt.clone().index_add_(axis, idx, src)
def _segment_sum(src, seg, n):
    out = torch.zeros((n,) + src.shape[1:], dtype=src.dtype)
    return out.index_add_(0, seg, src)
def _pad(x, pw):
    flat = tuple(v for pair in reversed(pw) for v in pair)
    return torch.nn.functional.pad(x, flat)

kernel_name = 'gated_mix__ssm_conv_s4__dense_activation_squared_relu__prompt'

def setup_inputs():

    _w = (lambda a: (lambda t: t.to(torch.bfloat16) if t.is_floating_point() else t)(torch.as_tensor(a)))
    def _A_setup():
        B, L, D, N = 1, 2048, 512, 128
        A_re = -(lambda _x: torch.exp(torch.as_tensor(_x)))((lambda *s: torch.randn(*s, dtype=torch.bfloat16) * 3.2)(D, N))
        A_im = torch.pi * (lambda *s: torch.randn(*s, dtype=torch.bfloat16) * 0.1)(D, N)
        B_re = (lambda *s: torch.randn(*s, dtype=torch.bfloat16) * 0.2)(D, N)
        B_im = (lambda *s: torch.randn(*s, dtype=torch.bfloat16) * 0.2)(D, N)
        C_re = (lambda *s: torch.randn(*s, dtype=torch.bfloat16) * 0.2)(D, N)
        C_im = (lambda *s: torch.randn(*s, dtype=torch.bfloat16) * 0.2)(D, N)
        log_dt = (lambda *s: torch.randn(*s, dtype=torch.bfloat16) * 0.1)(D) * 0.5 - 4.0
        Dskip = (lambda *s: torch.randn(*s, dtype=torch.bfloat16) * 0.1)(D)
        return {
            "u": _w((lambda *s: torch.randn(*s, dtype=torch.bfloat16) * 0.05)(B, L, D)),
            "A_re": _w(A_re),
            "A_im": _w(A_im),
            "B_re": _w(B_re),
            "B_im": _w(B_im),
            "C_re": _w(C_re),
            "C_im": _w(C_im),
            "log_dt": _w(log_dt),
            "Dskip": _w(Dskip),
        }
    _A_in = _A_setup()

    def _B_setup():
        B, S, D, F = 1, 2048, 512, 1376
        return {
            "x": _w((lambda *s: torch.randn(*s, dtype=torch.bfloat16) * 0.05)(B, S, D)),
            "w1": _w((lambda *s: torch.randn(*s, dtype=torch.bfloat16) * 0.05)(D, F)),
            "b1": _w((lambda *s: torch.randn(*s, dtype=torch.bfloat16) * 0.05)(F)),
            "w2": _w((lambda *s: torch.randn(*s, dtype=torch.bfloat16) * 0.05)(F, D)),
            "b2": _w((lambda *s: torch.randn(*s, dtype=torch.bfloat16) * 0.05)(D)),
        }
    _B_in = _B_setup()

    return {
        "A_u": _A_in["u"],
        "A_A_re": _A_in["A_re"],
        "A_A_im": _A_in["A_im"],
        "A_B_re": _A_in["B_re"],
        "A_B_im": _A_in["B_im"],
        "A_C_re": _A_in["C_re"],
        "A_C_im": _A_in["C_im"],
        "A_log_dt": _A_in["log_dt"],
        "A_Dskip": _A_in["Dskip"],
        "B_x": _B_in["x"],
        "B_w1": _B_in["w1"],
        "B_b1": _B_in["b1"],
        "B_w2": _B_in["w2"],
        "B_b2": _B_in["b2"],
        "gate_w": _w((lambda *s: torch.randn(*s, dtype=torch.bfloat16) * 0.05)(512) * 16.0),
    }

def reference(A_u, A_A_re, A_A_im, A_B_re, A_B_im, A_C_re, A_C_im, A_log_dt, A_Dskip, B_x, B_w1, B_b1, B_w2, B_b2, gate_w):
    def _A_ref(u, A_re, A_im, B_re, B_im, C_re, C_im, log_dt, Dskip):
        Bsz, L, D = u.shape
        dt = torch.exp(log_dt)[:, None]
        A = A_re + 1j * A_im
        Bc = B_re + 1j * B_im
        Cc = C_re + 1j * C_im
        logdA = dt * A
        dB = dt * Bc
        l = (lambda x, dt: x.to(dt))(torch.arange(L), A_re.dtype)
        P = torch.exp(logdA[:, :, None] * l[None, None, :])
        K = torch.einsum("dn,dnl,dn->dl", Cc, P, dB).real
        L2 = 2 * L
        Kp = _pad(K, ((0, 0), (0, L)))
        up = (lambda x, *d: x.permute(*d))(u, 0, 2, 1)
        up = _pad(up, ((0, 0), (0, 0), (0, L)))
        Kf = (lambda x, axes=(-2,-1): torch.fft.rfft2(x.float(), dim=axes))(Kp[:, None, :], axes=(-2, -1))
        Uf = (lambda x, axes=(-2,-1): torch.fft.rfft2(x.float(), dim=axes))(up[:, :, None, :], axes=(-2, -1))
        Yf = Uf * Kf[None, :, :, :]
        y = (lambda x, s, axes=(-2,-1): torch.fft.irfft2(x, s=s, dim=axes).to(torch.bfloat16))(Yf, (1, L2), axes=(-2, -1))[:, :, 0, :L]
        y = (lambda x, *d: x.permute(*d))(y, 0, 2, 1) + u * Dskip[None, None, :]
        return y

    def _B_ref(x, w1, b1, w2, b2):
        h = torch.einsum("bsd,df->bsf", x, w1) + b1
        zero = torch.zeros_like(h)
        r = torch.where(h > zero, h, zero)
        h = r * r
        out = torch.einsum("bsf,fd->bsd", h, w2) + b2
        return out

    x = A_u
    g = _sigmoid((x * gate_w).sum(-1, keepdims=True))
    a = _A_ref(x, A_A_re, A_A_im, A_B_re, A_B_im, A_C_re, A_C_im, A_log_dt, A_Dskip)
    b = _B_ref(x, B_w1, B_b1, B_w2, B_b2)
    return g * a + (1 - g) * b
```

```asm
; @launch grid=(256,1,1) block=(512,1,1) lds=163840
.amdgcn_target "amdgcn-amd-amdhsa--gfx950"
.text

.globl gated_mix__ssm_conv_s4__dense_activation_squared_relu__prompt_kernel
.p2align 8
.type gated_mix__ssm_conv_s4__dense_activation_squared_relu__prompt_kernel,@function
gated_mix__ssm_conv_s4__dense_activation_squared_relu__prompt_kernel:

    s_cmp_gt_u32 s2, 0xff
    s_cbranch_scc1 L_end
    s_getpc_b64 s[4:5]
L_pc:
    s_andn2_b32 s3, s2, 7
    v_lshrrev_b32 v1, 6, v0
    v_add_lshl_u32 v2, s3, v1, 7
    global_load_dword v255, v2, s[4:5]
    s_load_dwordx16 s[8:23], s[0:1], 0
    s_load_dwordx16 s[24:39], s[0:1], 64
    s_load_dwordx4 s[40:43], s[0:1], 128
    v_readfirstlane_b32 s64, v1
L_back:
    s_bfe_u32 s65, s2, 0x20001
    s_lshr_b32 s7, s2, 6
    s_lshl2_add_u32 s65, s65, s7
    s_and_b32 s66, s2, 1
    s_bfe_u32 s6, s2, 0x30003
    s_lshl3_add_u32 s66, s66, s6
    s_lshl1_add_u32 s69, s7, s66
    s_bitcmp1_b32 s2, 1
    s_addc_u32 s69, s69, 0
    s_lshl4_add_u32 s3, s66, s65
    s_lshl_b32 s6, s3, 8
    v_and_b32 v2, 0xff, v0
    v_add_lshl_u32 v2, v2, s6, 1
    v_lshrrev_b32 v4, 8, v2
    v_lshlrev_b32 v4, 1, v4
    v_and_b32 v0, 63, v0
    v_lshlrev_b32 v27, 2, v0
    v_and_b32 v29, 0x7c, v27
    v_add_u32 v29, 162944, v29
    v_mov_b32_e64 v228, 0
    ds_write_b32 v29, v228
    v_lshrrev_b32 v12, 3, v0
    v_and_b32 v13, 7, v0
    v_lshrrev_b32 v14, 4, v0
    v_xor_b32 v14, v13, v14
    v_lshlrev_b32_e64 v14, 4, v14
    v_lshl_add_u32 v240, v12, 10, v14
    s_cmp_lt_u32 s64, 4
    s_waitcnt lgkmcnt(0)
    global_load_ushort v22, v4, s[22:23]
    global_load_ushort v16, v2, s[10:11]
    global_load_ushort v17, v2, s[12:13]
    s_cbranch_scc1 L_F
    s_nop 0
    global_load_ushort v18, v2, s[14:15]
    global_load_ushort v19, v2, s[16:17]
    global_load_ushort v20, v2, s[18:19]
    global_load_ushort v21, v2, s[20:21]
    s_and_b32 s76, s66, 7
    s_lshl3_add_u32 s76, s65, s76
    s_lshl_b32 s76, s76, 4
    s_nop 0
    v_bfe_u32 v5, v2, 5, 4
    v_add_lshl_u32 v5, v5, s76, 10
    global_load_dword v253, v5, s[8:9] offset:384
    s_barrier
    s_setprio 3
    s_lshl_b32 s78, s3, 2
    v_xor_b32 v5, 0x1000, v2
    s_load_dword s7, s[24:25], s78
    s_branch L_C
L_F:
    v_xor_b32_e64 v14, 64, v240
    v_add_u32 v241, 7168, v14
    v_add_u32 v242, 14336, v240
    v_add_u32 v243, 21504, v14
    s_lshl_b32 s96, s64, 12
    s_lshl2_add_u32 s6, s65, s64
    s_lshl_b32 s6, s6, 15
    s_mov_b32 s46, 2097152
    s_mov_b32 s47, 0x20000
    s_and_b32 s79, s69, 7
    s_lshl_b32 s77, s79, 7
    s_add_u32 s77, s77, s6
    s_mov_b32 m0, s96
    s_mov_b64 s[44:45], s[8:9]
    s_barrier
    s_nop 0
    buffer_load_dwordx4 v240, s[44:47], s77 offen offset:0 lds
    buffer_load_dwordx4 v241, s[44:47], s77 offen offset:1024 lds
    buffer_load_dwordx4 v242, s[44:47], s77 offen offset:2048 lds
    buffer_load_dwordx4 v243, s[44:47], s77 offen offset:3072 lds
    s_load_dwordx2 s[72:73], s[42:43], 0
    v_lshrrev_b32 v12, 2, v0
    v_and_b32 v13, 3, v0
    v_mul_u32_u24 v12, 2752, v12
    v_lshl_add_u32 v12, v13, 4, v12
    s_lshr_b32 s3, 0x1249, s66
    s_lshl_b32 s3, s3, 31
    v_or_b32 v246, s3, v12
    v_add_u32 v245, 960, v12
    v_add_u32 v244, 1920, v12
    s_sub_u32 s48, s28, 1920
    s_subb_u32 s49, s29, 0
    s_nop 0
    s_mov_b32 s50, 1410944
    s_mov_b32 s51, 0x20000
    s_mul_i32 s97, s64, 3072
    s_add_u32 s97, s97, 65536
    s_mul_i32 s7, s64, 44032
    s_mul_i32 s76, s66, 172
    s_andn2_b32 s76, s76, 63
    s_add_u32 s7, s7, s76
    s_mul_i32 s76, s79, 176128
    s_add_u32 m0, s97, 12288
    s_add_u32 s76, s76, s7
    s_nop 0
    buffer_load_dwordx4 v244, s[48:51], s76 offen offset:0 lds
    buffer_load_dwordx4 v245, s[48:51], s76 offen offset:1024 lds
    buffer_load_dwordx4 v246, s[48:51], s76 offen offset:2048 lds
    s_and_b32 s76, s66, 1
    s_lshl1_add_u32 s67, s65, s76
    s_lshr_b32 s68, s66, 1
    v_lshlrev_b32 v1, 4, v0
    v_lshrrev_b32 v12, 3, v0
    v_and_b32 v13, 7, v0
    v_and_b32 v14, 2, v12
    v_lshlrev_b32 v14, 1, v14
    v_xor_b32 v14, v13, v14
    v_lshlrev_b32 v14, 4, v14
    v_lshl_add_u32 v2, v12, 10, v14
    s_cmp_eq_u32 s64, 3
    s_cselect_b32 s78, 0x80000000, 0
    v_or_b32 v252, s78, v2
    v_and_b32 v12, 31, v0
    v_lshrrev_b32 v13, 5, v0
    v_bfe_u32 v14, v0, 1, 3
    v_xor_b32 v14, v13, v14
    v_lshlrev_b32 v14, 4, v14
    v_lshl_add_u32 v14, v12, 7, v14
    v_add_u32 v247, s96, v14
    v_xor_b32 v248, 32, v247
    v_xor_b32_e64 v249, 64, v247
    v_xor_b32 v250, 0x60, v247
    v_bfe_u32 v12, v0, 2, 2
    v_bfe_u32 v14, v0, 4, 1
    v_and_b32 v15, 3, v0
    v_lshlrev_b32 v15, 3, v15
    v_lshl_add_u32 v15, v14, 5, v15
    v_lshl_add_u32 v14, v13, 3, v12
    v_mul_u32_u24 v14, 64, v14
    v_add_u32 v14, v14, v15
    v_add_u32 v251, 65536, v14
    v_lshl_add_u32 v14, v13, 2, v12
    v_lshl_add_u32 v14, v14, 7, v15
    v_and_b32 v12, 2, v12
    v_lshlrev_b32 v12, 5, v12
    v_xor_b32 v14, v14, v12
    v_add_u32 v3, s96, v14
    v_xor_b32 v4, 64, v3
    v_add_u32 v5, s97, v14
    v_xor_b32 v6, 64, v5
    v_and_b32 v7, 31, v0
    v_lshlrev_b32_e64 v7, 1, v7
    v_add_u32 v7, 162304, v7
    v_cmp_gt_u32_e64 vcc, 32, v0
    v_mov_b32 v12, 0x3f80
    v_mov_b32 v81, 0
    v_mov_b32 v82, 0
    v_mov_b32 v83, 0
    v_mov_b32 v85, 0
    v_mov_b32 v86, 0
    v_mov_b32 v87, 0
    v_mov_b32 v89, 0
    v_mov_b32 v90, 0
    v_mov_b32 v91, 0
    v_mov_b32 v93, 0
    v_mov_b32 v94, 0
    v_mov_b32 v95, 0
    v_cndmask_b32 v92, 0, v12, vcc
    s_mul_i32 s78, s64, 22
    s_min_u32 s78, s78, 64
    s_lshl_b32 s98, s78, 14
    s_lshl_b32 s78, s68, 7
    s_add_u32 s98, s98, s78
    s_mov_b32 s52, s32
    s_mov_b32 s53, s33
    s_mov_b32 s54, 1409024
    s_mov_b32 s55, 0x20000
    s_mov_b32 s56, s42
    s_mov_b32 s57, s43
    s_mov_b32 s58, 16777216
    s_mov_b32 s59, 0x20000
    v_lshrrev_b32_e64 v37, 3, v0
    v_bfe_u32 v38, v0, 2, 1
    v_lshl_add_u32 v37, v37, 2, v38
    v_and_b32_e64 v38, 1, v0
    v_bfe_u32 v39, v0, 1, 1
    v_lshl_add_u32 v33, v38, 1, v39
    v_lshlrev_b32_e64 v38, 4, v33
    v_lshl_add_u32 v116, v37, 12, v38
    v_lshrrev_b32 v37, 4, v0
    s_lshr_b32 s76, s66, 3
    s_lshl_b32 s76, s76, 2
    v_add_u32 v37, s76, v37
    v_bfe_u32 v38, v0, 3, 1
    v_xor_b32 v37, v37, v38
    v_lshlrev_b32 v117, 4, v37
    v_lshl_add_u32 v117, v39, 3, v117
    v_bfe_u32 v37, v0, 2, 2
    v_lshl_add_u32 v117, v37, 7, v117
    v_and_b32_e64 v37, 1, v0
    v_lshl_add_u32 v117, v37, 11, v117
    v_add_u32_e64 v117, s96, v117
    s_mov_b32 s76, 123392
    s_cmp_eq_u32 s64, 1
    s_cselect_b32 s76, 141568, s76
    s_cmp_eq_u32 s64, 2
    s_cselect_b32 s76, 132096, s76
    s_cmp_eq_u32 s64, 3
    s_cselect_b32 s76, 151808, s76
    s_mov_b32 s77, 127744
    s_cmp_eq_u32 s64, 1
    s_cselect_b32 s77, 146688, s77
    s_cmp_eq_u32 s64, 2
    s_cselect_b32 s77, 136448, s77
    s_cmp_eq_u32 s64, 3
    s_cselect_b32 s77, 156928, s77
    v_lshl_add_u32 v64, v0, 2, s76
    v_lshl_add_u32 v65, v0, 2, s77
    s_and_b32 s76, s64, 2
    s_add_u32 s76, s76, s64
    s_lshl2_add_u32 s78, s76, 163016
    v_mov_b32_e64 v66, s78
    v_mov_b32 v26, 0x3fb8aa3b
    s_waitcnt vmcnt(7)
    v_lshlrev_b32 v27, 16, v22
    v_mul_f32 v27, v27, v26
    v_exp_f32 v27, v27
    v_lshlrev_b32 v24, 16, v16
    v_lshlrev_b32 v25, 16, v17
    v_cvt_pk_bf16_f32 v27, v27, v27
    v_mul_f32 v26, 0x41000000, v26
    v_lshlrev_b32 v27, 16, v27
    v_mul_f32 v24, v27, v24
    v_mul_f32 v25, v27, v25
    v_mul_f32 v24, v24, v26
    v_mul_f32 v25, 0x3fa2f983, v25
    v_exp_f32 v24, v24
    v_fract_f32 v25, v25
    v_cos_f32 v28, v25
    v_sin_f32 v29, v25
    v_mul_f32 v36, v24, v28
    v_mul_f32 v37, v24, v29
    v_mov_b32 v40, 1.0
    v_mov_b32 v41, 0
    v_mov_b32 v42, v36
    v_mov_b32 v43, v37
    v_pk_mul_f32 v[44:45], v[36:37], v[36:37] op_sel:[0,0] op_sel_hi:[1,0]
    v_pk_fma_f32 v[44:45], v[36:37], v[36:37], v[44:45] op_sel:[1,1,0] op_sel_hi:[0,1,1] neg_lo:[1,0,0]
    v_pk_mul_f32 v[46:47], v[44:45], v[36:37] op_sel:[0,0] op_sel_hi:[1,0]
    v_pk_mul_f32 v[38:39], v[44:45], v[44:45] op_sel:[0,0] op_sel_hi:[1,0]
    v_pk_fma_f32 v[46:47], v[44:45], v[36:37], v[46:47] op_sel:[1,1,0] op_sel_hi:[0,1,1] neg_lo:[1,0,0]
    v_pk_fma_f32 v[38:39], v[44:45], v[44:45], v[38:39] op_sel:[1,1,0] op_sel_hi:[0,1,1] neg_lo:[1,0,0]
    v_cvt_pk_bf16_f32 v56, v40, v41
    v_cvt_pk_bf16_f32 v57, v42, v43
    v_cvt_pk_bf16_f32 v58, v44, v45
    v_cvt_pk_bf16_f32 v59, v46, v47
    ds_write2_b32 v64, v56, v57 offset0:0 offset1:68
    ds_write2_b32 v64, v58, v59 offset0:136 offset1:204
    v_pk_mul_f32 v[48:49], v[40:41], v[38:39] op_sel:[0,0] op_sel_hi:[1,0]
    v_pk_mul_f32 v[50:51], v[42:43], v[38:39] op_sel:[0,0] op_sel_hi:[1,0]
    v_pk_mul_f32 v[52:53], v[44:45], v[38:39] op_sel:[0,0] op_sel_hi:[1,0]
    v_pk_mul_f32 v[54:55], v[46:47], v[38:39] op_sel:[0,0] op_sel_hi:[1,0]
    v_pk_fma_f32 v[48:49], v[40:41], v[38:39], v[48:49] op_sel:[1,1,0] op_sel_hi:[0,1,1] neg_lo:[1,0,0]
    v_pk_fma_f32 v[50:51], v[42:43], v[38:39], v[50:51] op_sel:[1,1,0] op_sel_hi:[0,1,1] neg_lo:[1,0,0]
    v_pk_fma_f32 v[52:53], v[44:45], v[38:39], v[52:53] op_sel:[1,1,0] op_sel_hi:[0,1,1] neg_lo:[1,0,0]
    v_pk_fma_f32 v[54:55], v[46:47], v[38:39], v[54:55] op_sel:[1,1,0] op_sel_hi:[0,1,1] neg_lo:[1,0,0]
    v_cvt_pk_bf16_f32 v60, v48, v49
    v_cvt_pk_bf16_f32 v61, v50, v51
    v_cvt_pk_bf16_f32 v62, v52, v53
    v_cvt_pk_bf16_f32 v63, v54, v55
    v_add_u32 v64, 1088, v64
    ds_write2_b32 v64, v60, v61 offset0:0 offset1:68
    ds_write2_b32 v64, v62, v63 offset0:136 offset1:204
    v_pk_mul_f32 v[40:41], v[48:49], v[38:39] op_sel:[0,0] op_sel_hi:[1,0]
    v_pk_mul_f32 v[42:43], v[50:51], v[38:39] op_sel:[0,0] op_sel_hi:[1,0]
    v_pk_mul_f32 v[44:45], v[52:53], v[38:39] op_sel:[0,0] op_sel_hi:[1,0]
    v_pk_mul_f32 v[46:47], v[54:55], v[38:39] op_sel:[0,0] op_sel_hi:[1,0]
    v_pk_fma_f32 v[40:41], v[48:49], v[38:39], v[40:41] op_sel:[1,1,0] op_sel_hi:[0,1,1] neg_lo:[1,0,0]
    v_pk_fma_f32 v[42:43], v[50:51], v[38:39], v[42:43] op_sel:[1,1,0] op_sel_hi:[0,1,1] neg_lo:[1,0,0]
    v_pk_fma_f32 v[44:45], v[52:53], v[38:39], v[44:45] op_sel:[1,1,0] op_sel_hi:[0,1,1] neg_lo:[1,0,0]
    v_pk_fma_f32 v[46:47], v[54:55], v[38:39], v[46:47] op_sel:[1,1,0] op_sel_hi:[0,1,1] neg_lo:[1,0,0]
    v_cvt_pk_bf16_f32 v56, v40, v41
    v_cvt_pk_bf16_f32 v57, v42, v43
    v_cvt_pk_bf16_f32 v58, v44, v45
    v_cvt_pk_bf16_f32 v59, v46, v47
    v_add_u32 v64, 1088, v64
    ds_write2_b32 v64, v56, v57 offset0:0 offset1:68
    ds_write2_b32 v64, v58, v59 offset0:136 offset1:204
    v_pk_mul_f32 v[48:49], v[40:41], v[38:39] op_sel:[0,0] op_sel_hi:[1,0]
    v_pk_mul_f32 v[50:51], v[42:43], v[38:39] op_sel:[0,0] op_sel_hi:[1,0]
    v_pk_mul_f32 v[52:53], v[44:45], v[38:39] op_sel:[0,0] op_sel_hi:[1,0]
    v_pk_mul_f32 v[54:55], v[46:47], v[38:39] op_sel:[0,0] op_sel_hi:[1,0]
    v_pk_fma_f32 v[48:49], v[40:41], v[38:39], v[48:49] op_sel:[1,1,0] op_sel_hi:[0,1,1] neg_lo:[1,0,0]
    v_pk_fma_f32 v[50:51], v[42:43], v[38:39], v[50:51] op_sel:[1,1,0] op_sel_hi:[0,1,1] neg_lo:[1,0,0]
    v_pk_fma_f32 v[52:53], v[44:45], v[38:39], v[52:53] op_sel:[1,1,0] op_sel_hi:[0,1,1] neg_lo:[1,0,0]
    v_pk_fma_f32 v[54:55], v[46:47], v[38:39], v[54:55] op_sel:[1,1,0] op_sel_hi:[0,1,1] neg_lo:[1,0,0]
    v_cvt_pk_bf16_f32 v60, v48, v49
    v_cvt_pk_bf16_f32 v61, v50, v51
    v_cvt_pk_bf16_f32 v62, v52, v53
    v_cvt_pk_bf16_f32 v63, v54, v55
    v_add_u32 v64, 1088, v64
    ds_write2_b32 v64, v60, v61 offset0:0 offset1:68
    ds_write2_b32 v64, v62, v63 offset0:136 offset1:204
    v_pk_mul_f32 v[40:41], v[48:49], v[38:39] op_sel:[0,0] op_sel_hi:[1,0]
    v_pk_mul_f32 v[42:43], v[50:51], v[38:39] op_sel:[0,0] op_sel_hi:[1,0]
    v_pk_mul_f32 v[44:45], v[52:53], v[38:39] op_sel:[0,0] op_sel_hi:[1,0]
    v_pk_mul_f32 v[46:47], v[54:55], v[38:39] op_sel:[0,0] op_sel_hi:[1,0]
    v_pk_fma_f32 v[40:41], v[48:49], v[38:39], v[40:41] op_sel:[1,1,0] op_sel_hi:[0,1,1] neg_lo:[1,0,0]
    v_pk_fma_f32 v[42:43], v[50:51], v[38:39], v[42:43] op_sel:[1,1,0] op_sel_hi:[0,1,1] neg_lo:[1,0,0]
    v_pk_fma_f32 v[44:45], v[52:53], v[38:39], v[44:45] op_sel:[1,1,0] op_sel_hi:[0,1,1] neg_lo:[1,0,0]
    v_pk_fma_f32 v[46:47], v[54:55], v[38:39], v[46:47] op_sel:[1,1,0] op_sel_hi:[0,1,1] neg_lo:[1,0,0]
    v_cvt_pk_bf16_f32 v56, v40, v41
    v_cvt_pk_bf16_f32 v57, v42, v43
    v_cvt_pk_bf16_f32 v58, v44, v45
    v_cvt_pk_bf16_f32 v59, v46, v47
    ds_write2_b32 v65, v56, v57 offset0:0 offset1:68
    ds_write2_b32 v65, v58, v59 offset0:136 offset1:204
    v_pk_mul_f32 v[48:49], v[40:41], v[38:39] op_sel:[0,0] op_sel_hi:[1,0]
    v_pk_mul_f32 v[50:51], v[42:43], v[38:39] op_sel:[0,0] op_sel_hi:[1,0]
    v_pk_mul_f32 v[52:53], v[44:45], v[38:39] op_sel:[0,0] op_sel_hi:[1,0]
    v_pk_mul_f32 v[54:55], v[46:47], v[38:39] op_sel:[0,0] op_sel_hi:[1,0]
    v_pk_fma_f32 v[48:49], v[40:41], v[38:39], v[48:49] op_sel:[1,1,0] op_sel_hi:[0,1,1] neg_lo:[1,0,0]
    v_pk_fma_f32 v[50:51], v[42:43], v[38:39], v[50:51] op_sel:[1,1,0] op_sel_hi:[0,1,1] neg_lo:[1,0,0]
    v_pk_fma_f32 v[52:53], v[44:45], v[38:39], v[52:53] op_sel:[1,1,0] op_sel_hi:[0,1,1] neg_lo:[1,0,0]
    v_pk_fma_f32 v[54:55], v[46:47], v[38:39], v[54:55] op_sel:[1,1,0] op_sel_hi:[0,1,1] neg_lo:[1,0,0]
    v_cvt_pk_bf16_f32 v60, v48, v49
    v_cvt_pk_bf16_f32 v61, v50, v51
    v_cvt_pk_bf16_f32 v62, v52, v53
    v_cvt_pk_bf16_f32 v63, v54, v55
    v_add_u32 v65, 1088, v65
    ds_write2_b32 v65, v60, v61 offset0:0 offset1:68
    ds_write2_b32 v65, v62, v63 offset0:136 offset1:204
    v_pk_mul_f32 v[40:41], v[48:49], v[38:39] op_sel:[0,0] op_sel_hi:[1,0]
    v_pk_mul_f32 v[42:43], v[50:51], v[38:39] op_sel:[0,0] op_sel_hi:[1,0]
    v_pk_mul_f32 v[44:45], v[52:53], v[38:39] op_sel:[0,0] op_sel_hi:[1,0]
    v_pk_mul_f32 v[46:47], v[54:55], v[38:39] op_sel:[0,0] op_sel_hi:[1,0]
    v_pk_fma_f32 v[40:41], v[48:49], v[38:39], v[40:41] op_sel:[1,1,0] op_sel_hi:[0,1,1] neg_lo:[1,0,0]
    v_pk_fma_f32 v[42:43], v[50:51], v[38:39], v[42:43] op_sel:[1,1,0] op_sel_hi:[0,1,1] neg_lo:[1,0,0]
    v_pk_fma_f32 v[44:45], v[52:53], v[38:39], v[44:45] op_sel:[1,1,0] op_sel_hi:[0,1,1] neg_lo:[1,0,0]
    v_pk_fma_f32 v[46:47], v[54:55], v[38:39], v[46:47] op_sel:[1,1,0] op_sel_hi:[0,1,1] neg_lo:[1,0,0]
    v_cvt_pk_bf16_f32 v56, v40, v41
    v_cvt_pk_bf16_f32 v57, v42, v43
    v_cvt_pk_bf16_f32 v58, v44, v45
    v_cvt_pk_bf16_f32 v59, v46, v47
    v_add_u32 v65, 1088, v65
    ds_write2_b32 v65, v56, v57 offset0:0 offset1:68
    ds_write2_b32 v65, v58, v59 offset0:136 offset1:204
    v_pk_mul_f32 v[48:49], v[40:41], v[38:39] op_sel:[0,0] op_sel_hi:[1,0]
    v_pk_mul_f32 v[50:51], v[42:43], v[38:39] op_sel:[0,0] op_sel_hi:[1,0]
    v_pk_mul_f32 v[52:53], v[44:45], v[38:39] op_sel:[0,0] op_sel_hi:[1,0]
    v_pk_mul_f32 v[54:55], v[46:47], v[38:39] op_sel:[0,0] op_sel_hi:[1,0]
    v_pk_fma_f32 v[48:49], v[40:41], v[38:39], v[48:49] op_sel:[1,1,0] op_sel_hi:[0,1,1] neg_lo:[1,0,0]
    v_pk_fma_f32 v[50:51], v[42:43], v[38:39], v[50:51] op_sel:[1,1,0] op_sel_hi:[0,1,1] neg_lo:[1,0,0]
    v_pk_fma_f32 v[52:53], v[44:45], v[38:39], v[52:53] op_sel:[1,1,0] op_sel_hi:[0,1,1] neg_lo:[1,0,0]
    v_pk_fma_f32 v[54:55], v[46:47], v[38:39], v[54:55] op_sel:[1,1,0] op_sel_hi:[0,1,1] neg_lo:[1,0,0]
    v_cvt_pk_bf16_f32 v60, v48, v49
    v_cvt_pk_bf16_f32 v61, v50, v51
    v_cvt_pk_bf16_f32 v62, v52, v53
    v_cvt_pk_bf16_f32 v63, v54, v55
    s_waitcnt lgkmcnt(6)
    s_nop 0
    v_add_u32 v65, 1088, v65
    ds_write2_b32 v65, v60, v61 offset0:0 offset1:68
    ds_write2_b32 v65, v62, v63 offset0:136 offset1:204
    ds_write_b32 v66, v66
    s_add_u32 s77, s69, 1
    s_and_b32 s77, s77, 7
    s_mul_i32 s76, s77, 176128
    s_add_u32 m0, s97, 24576
    s_add_u32 s76, s76, s7
    s_nop 0
    buffer_load_dwordx4 v244, s[48:51], s76 offen offset:0 lds
    buffer_load_dwordx4 v245, s[48:51], s76 offen offset:1024 lds
    buffer_load_dwordx4 v246, s[48:51], s76 offen offset:2048 lds
    s_lshl_b32 s77, s77, 7
    s_add_u32 m0, s96, 16384
    s_add_u32 s77, s77, s6
    buffer_load_dwordx4 v240, s[44:47], s77 offen offset:0 lds
    buffer_load_dwordx4 v241, s[44:47], s77 offen offset:1024 lds
    buffer_load_dwordx4 v242, s[44:47], s77 offen offset:2048 lds
    buffer_load_dwordx4 v243, s[44:47], s77 offen offset:3072 lds
    s_waitcnt lgkmcnt(0)
    s_mul_i32 s74, s72, 0x9E3779B1
    s_mul_i32 s75, s73, 0x85EBCA77
    s_add_u32 s74, s74, s75
    s_add_u32 s74, s74, 0x27D4EB2F
    s_lshr_b32 s75, s74, 15
    s_xor_b32 s74, s74, s75
    s_mul_i32 s74, s74, 0xC2B2AE3D
    s_lshr_b32 s75, s74, 13
    s_xor_b32 s74, s74, s75
    s_mul_i32 s75, s74, 0x165667B1
    s_or_b32 s74, s74, 0x55555555
    s_or_b32 s75, s75, 0x55555555
    s_xor_b32 s70, s72, s74
    s_xor_b32 s71, s73, s75
    s_mov_b32 s74, 0
    s_andn2_b32 s12, 0x11111111, s70
    s_and_b32 s13, s70, 0xdddddddd
    s_lshl1_add_u32 s12, s12, s13
    s_andn2_b32 s13, 0x11111111, s71
    s_and_b32 s76, s71, 0xdddddddd
    s_lshl1_add_u32 s13, s13, s76
    v_mov_b32 v39, s13
    v_mov_b32 v37, 162560
    ds_write_b32 v37, v39
    v_lshlrev_b32_e64 v37, 1, v0
    v_lshrrev_b32_e64 v37, v37, s12
    v_lshlrev_b32 v38, 15, v37
    v_lshlrev_b32 v37, 30, v37
    v_and_b32 v38, 0x8000, v38
    v_and_b32 v37, 0x80000000, v37
    v_or_b32_e64 v8, v37, v38
    s_mov_b32 s75, 0x7fff7fff
    s_mov_b32 s22, 0x20002000
    s_mov_b32 s23, 0x5fff5fff
    s_lshl_b32 s76, s64, 2
    v_add_u32 v33, s76, v33
    v_lshlrev_b32 v38, 1, v33
    v_lshrrev_b32 v38, v38, v39
    v_bfe_u32 v40, v38, 1, 1
    v_and_b32_e64 v38, 1, v38
    v_lshl_or_b32 v38, v40, 16, v38
    v_lshlrev_b32 v112, 14, v38
    s_waitcnt vmcnt(10)
    ds_read_b64_tr_b16 v[96:97], v117 offset:0
    v_xor_b32_e64 v37, 32, v117
    ds_read_b64_tr_b16 v[98:99], v37 offset:512
    v_xor_b32_e64 v37, 64, v117
    ds_read_b64_tr_b16 v[100:101], v37 offset:1024
    v_xor_b32 v37, 96, v117
    ds_read_b64_tr_b16 v[102:103], v37 offset:1536
    v_and_b32 v37, 2, v0
    v_cmp_eq_u32_e64 vcc, 0, v37
    s_and_b32 s76, s69, 7
    s_lshl_b32 s76, s76, 18
    s_lshr_b32 s77, s66, 3
    s_lshl_b32 s77, s77, 17
    s_add_u32 s76, s76, s77
    s_lshr_b32 s77, s6, 9
    s_add_u32 s76, s76, s77
    s_add_u32 s10, s76, 1048576
    s_add_u32 s11, s10, 8192
    s_waitcnt lgkmcnt(0)
    s_nop 0
    v_cndmask_b32_dpp v104, v100, v96, vcc quad_perm:[0,1,0,1] row_mask:0xf bank_mask:0xf
    v_cndmask_b32_dpp v105, v101, v97, vcc quad_perm:[0,1,0,1] row_mask:0xf bank_mask:0xf
    v_cndmask_b32_dpp v106, v102, v98, vcc quad_perm:[0,1,0,1] row_mask:0xf bank_mask:0xf
    v_cndmask_b32_dpp v107, v103, v99, vcc quad_perm:[0,1,0,1] row_mask:0xf bank_mask:0xf
    s_not_b64 vcc, vcc
    s_nop 0
    v_cndmask_b32_dpp v108, v96, v100, vcc quad_perm:[2,3,2,3] row_mask:0xf bank_mask:0xf
    v_cndmask_b32_dpp v109, v97, v101, vcc quad_perm:[2,3,2,3] row_mask:0xf bank_mask:0xf
    v_cndmask_b32_dpp v110, v98, v102, vcc quad_perm:[2,3,2,3] row_mask:0xf bank_mask:0xf
    v_cndmask_b32_dpp v111, v99, v103, vcc quad_perm:[2,3,2,3] row_mask:0xf bank_mask:0xf
    s_mov_b32 vcc_lo, 0xf5f5f5f5
    s_mov_b32 vcc_hi, 0xf5f5f5f5
    v_cndmask_b32_dpp v96, v104, v104, vcc row_shl:3 row_mask:0xf bank_mask:0xf bound_ctrl:0
    v_cndmask_b32_dpp v97, v105, v105, vcc row_shl:3 row_mask:0xf bank_mask:0xf bound_ctrl:0
    v_cndmask_b32_dpp v98, v106, v106, vcc row_shl:3 row_mask:0xf bank_mask:0xf bound_ctrl:0
    v_cndmask_b32_dpp v99, v107, v107, vcc row_shl:3 row_mask:0xf bank_mask:0xf bound_ctrl:0
    v_cndmask_b32_dpp v100, v108, v108, vcc row_shl:3 row_mask:0xf bank_mask:0xf bound_ctrl:0
    v_cndmask_b32_dpp v101, v109, v109, vcc row_shl:3 row_mask:0xf bank_mask:0xf bound_ctrl:0
    v_cndmask_b32_dpp v102, v110, v110, vcc row_shl:3 row_mask:0xf bank_mask:0xf bound_ctrl:0
    v_cndmask_b32_dpp v103, v111, v111, vcc row_shl:3 row_mask:0xf bank_mask:0xf bound_ctrl:0
    s_mov_b32 vcc_lo, 0xafafafaf
    s_mov_b32 vcc_hi, 0xafafafaf
    v_cndmask_b32_dpp v96, v104, v96, vcc row_shr:3 row_mask:0xf bank_mask:0xf bound_ctrl:0
    v_cndmask_b32_dpp v97, v105, v97, vcc row_shr:3 row_mask:0xf bank_mask:0xf bound_ctrl:0
    v_cndmask_b32_dpp v98, v106, v98, vcc row_shr:3 row_mask:0xf bank_mask:0xf bound_ctrl:0
    v_cndmask_b32_dpp v99, v107, v99, vcc row_shr:3 row_mask:0xf bank_mask:0xf bound_ctrl:0
    v_cndmask_b32_dpp v100, v108, v100, vcc row_shr:3 row_mask:0xf bank_mask:0xf bound_ctrl:0
    v_cndmask_b32_dpp v101, v109, v101, vcc row_shr:3 row_mask:0xf bank_mask:0xf bound_ctrl:0
    v_cndmask_b32_dpp v102, v110, v102, vcc row_shr:3 row_mask:0xf bank_mask:0xf bound_ctrl:0
    v_cndmask_b32_dpp v103, v111, v103, vcc row_shr:3 row_mask:0xf bank_mask:0xf bound_ctrl:0
    s_add_u32 s76, s69, 2
    s_and_b32 s76, s76, 7
    s_lshl_b32 s77, s76, 7
    s_add_u32 s77, s77, s6
    s_add_u32 m0, s96, 32768
    s_mul_i32 s76, s76, 176128
    buffer_load_dwordx4 v240, s[44:47], s77 offen offset:0 lds
    buffer_load_dwordx4 v241, s[44:47], s77 offen offset:1024 lds
    buffer_load_dwordx4 v242, s[44:47], s77 offen offset:2048 lds
    buffer_load_dwordx4 v243, s[44:47], s77 offen offset:3072 lds
    s_add_u32 m0, s97, 36864
    s_add_u32 s76, s76, s7
    s_nop 0
    buffer_load_dwordx4 v244, s[48:51], s76 offen offset:0 lds
    buffer_load_dwordx4 v245, s[48:51], s76 offen offset:1024 lds
    buffer_load_dwordx4 v246, s[48:51], s76 offen offset:2048 lds
    s_waitcnt vmcnt(14)
    s_barrier
    ds_read_b128 v[220:223], v247 offset:0
    ds_read_b64_tr_b16 v[208:209], v251 offset:12288
    ds_read_b64_tr_b16 v[210:211], v251 offset:12544
    ds_read_b64_tr_b16 v[212:213], v251 offset:13312
    ds_read_b64_tr_b16 v[214:215], v251 offset:13568
    ds_read_b64_tr_b16 v[216:217], v251 offset:14336
    ds_read_b64_tr_b16 v[218:219], v251 offset:14592
    ds_read_b128 v[236:239], v248 offset:0
    ds_read_b64_tr_b16 v[224:225], v251 offset:15360
    ds_read_b64_tr_b16 v[226:227], v251 offset:15616
    ds_read_b64_tr_b16 v[228:229], v251 offset:16384
    ds_read_b64_tr_b16 v[230:231], v251 offset:16640
    ds_read_b64_tr_b16 v[232:233], v251 offset:17408
    ds_read_b64_tr_b16 v[234:235], v251 offset:17664
    s_add_u32 s76, s69, 3
    s_and_b32 s76, s76, 7
    s_lshl_b32 s77, s76, 7
    s_add_u32 s77, s77, s6
    s_add_u32 m0, s96, 49152
    s_mul_i32 s76, s76, 176128
    buffer_load_dwordx4 v240, s[44:47], s77 offen offset:0 lds
    buffer_load_dwordx4 v241, s[44:47], s77 offen offset:1024 lds
    buffer_load_dwordx4 v242, s[44:47], s77 offen offset:2048 lds
    s_waitcnt lgkmcnt(11)
    v_mfma_f32_32x32x16_bf16 v[160:175], v[208:211], v[220:223], 0
    v_and_b32 v104, s75, v96
    v_and_b32 v105, s75, v97
    v_and_b32 v106, s75, v98
    v_and_b32 v107, s75, v99
    v_and_b32 v108, s75, v100
    v_and_b32_e64 v109, s75, v101
    ds_read_b128 v[28:31], v249 offset:0
    ds_read_b64_tr_b16 v[16:17], v251 offset:18432
    ds_read_b64_tr_b16 v[18:19], v251 offset:18688
    ds_read_b64_tr_b16 v[20:21], v251 offset:19456
    s_waitcnt lgkmcnt(6)
    s_nop 0
    ds_read_b64_tr_b16 v[22:23], v251 offset:19712
    ds_read_b64_tr_b16 v[24:25], v251 offset:20480
    ds_read_b64_tr_b16 v[26:27], v251 offset:20736
    v_mfma_f32_32x32x16_bf16 v[176:191], v[212:215], v[220:223], 0
    v_and_b32 v110, s75, v102
    v_and_b32 v111, s75, v103
    v_pk_max_u16 v104, v104, s22
    v_pk_max_u16 v105, v105, s22
    v_pk_max_u16 v106, v106, s22
    v_pk_max_u16 v107, v107, s22
    buffer_load_dwordx4 v243, s[44:47], s77 offen offset:3072 lds
    v_mfma_f32_32x32x16_bf16 v[192:207], v[216:219], v[220:223], 0
    v_pk_max_u16 v108, v108, s22
    v_pk_max_u16 v109, v109, s22
    v_pk_max_u16 v110, v110, s22
    v_pk_max_u16 v111, v111, s22
    v_pk_min_u16 v104, v104, s23
    v_pk_min_u16 v105, v105, s23
    s_add_u32 m0, s97, 0
    s_add_u32 s76, s76, s7
    buffer_load_dwordx4 v244, s[48:51], s76 offen offset:0 lds
    v_mfma_f32_32x32x16_bf16 v[160:175], v[224:227], v[236:239], v[160:175]
    v_pk_min_u16 v106, v106, s23
    v_pk_min_u16 v107, v107, s23
    v_pk_min_u16 v108, v108, s23
    v_pk_min_u16 v109, v109, s23
    v_pk_min_u16 v110, v110, s23
    v_pk_min_u16 v111, v111, s23
    ds_read_b128 v[220:223], v250 offset:0
    ds_read_b64_tr_b16 v[208:209], v251 offset:21504
    ds_read_b64_tr_b16 v[210:211], v251 offset:21760
    ds_read_b64_tr_b16 v[212:213], v251 offset:22528
    ds_read_b64_tr_b16 v[214:215], v251 offset:22784
    ds_read_b64_tr_b16 v[216:217], v251 offset:23552
    s_waitcnt lgkmcnt(6)
    s_nop 0
    ds_read_b64_tr_b16 v[218:219], v251 offset:23808
    v_mfma_f32_32x32x16_bf16 v[176:191], v[228:231], v[236:239], v[176:191]
    v_bfi_b32 v96, s75, v104, v96
    v_bfi_b32 v97, s75, v105, v97
    v_bfi_b32 v98, s75, v106, v98
    v_bfi_b32 v99, s75, v107, v99
    v_bfi_b32 v100, s75, v108, v100
    v_bfi_b32 v101, s75, v109, v101
    buffer_load_dwordx4 v245, s[48:51], s76 offen offset:1024 lds
    v_mfma_f32_32x32x16_bf16 v[192:207], v[232:235], v[236:239], v[192:207]
    v_bfi_b32 v102, s75, v110, v102
    v_bfi_b32 v103, s75, v111, v103
    v_xor_b32 v96, v112, v96
    v_xor_b32 v100, v112, v100
    buffer_load_dwordx4 v246, s[48:51], s76 offen offset:2048 lds
    v_mfma_f32_32x32x16_bf16 v[160:175], v[16:19], v[28:31], v[160:175]
    buffer_store_dwordx4 v[96:99], v116, s[56:59], s10 offen sc1
    buffer_store_dwordx4 v[100:103], v116, s[56:59], s11 offen sc1
    s_waitcnt lgkmcnt(0)
    s_waitcnt vmcnt(16)
    s_barrier
    s_nop 0
    ds_read_b128 v[236:239], v247 offset:16384
    ds_read_b64_tr_b16 v[224:225], v251 offset:24576
    ds_read_b64_tr_b16 v[226:227], v251 offset:24832
    ds_read_b64_tr_b16 v[228:229], v251 offset:25600
    ds_read_b64_tr_b16 v[230:231], v251 offset:25856
    ds_read_b64_tr_b16 v[232:233], v251 offset:26624
    ds_read_b64_tr_b16 v[234:235], v251 offset:26880
    v_mfma_f32_32x32x16_bf16 v[176:191], v[20:23], v[28:31], v[176:191]
    s_add_u32 s76, s69, 4
    s_and_b32 s76, s76, 7
    s_lshl_b32 s77, s76, 7
    s_add_u32 s77, s77, s6
    s_add_u32 m0, s96, 0
    s_nop 0
    s_mul_i32 s76, s76, 176128
    buffer_load_dwordx4 v240, s[44:47], s77 offen offset:0 lds
    v_mfma_f32_32x32x16_bf16 v[192:207], v[24:27], v[28:31], v[192:207]
    ds_read_u16 v80, v7 offset:0
    ds_read_u16 v84, v7 offset:64
    ds_read_u16 v88, v7 offset:128
    buffer_load_dwordx4 v241, s[44:47], s77 offen offset:1024 lds
    v_mfma_f32_32x32x16_bf16 v[160:175], v[208:211], v[220:223], v[160:175]
    s_waitcnt lgkmcnt(0)
    s_nop 0
    v_mfma_f32_32x32x16_bf16 v[160:175], v[80:83], v[92:95], v[160:175]
    ds_read_b128 v[28:31], v248 offset:16384
    ds_read_b64_tr_b16 v[16:17], v251 offset:27648
    ds_read_b64_tr_b16 v[18:19], v251 offset:27904
    ds_read_b64_tr_b16 v[20:21], v251 offset:28672
    ds_read_b64_tr_b16 v[22:23], v251 offset:28928
    ds_read_b64_tr_b16 v[24:25], v251 offset:29696
    ds_read_b64_tr_b16 v[26:27], v251 offset:29952
    v_mfma_f32_32x32x16_bf16 v[176:191], v[212:215], v[220:223], v[176:191]
    v_mfma_f32_32x32x16_bf16 v[176:191], v[84:87], v[92:95], v[176:191]
    buffer_load_dwordx4 v242, s[44:47], s77 offen offset:2048 lds
    v_mfma_f32_32x32x16_bf16 v[192:207], v[216:219], v[220:223], v[192:207]
    v_mfma_f32_32x32x16_bf16 v[192:207], v[88:91], v[92:95], v[192:207]
    buffer_load_dwordx4 v243, s[44:47], s77 offen offset:3072 lds
    v_mfma_f32_32x32x16_bf16 v[160:175], v[224:227], v[236:239], v[160:175]
    ds_read_b128 v[220:223], v249 offset:16384
    ds_read_b64_tr_b16 v[208:209], v251 offset:30720
    ds_read_b64_tr_b16 v[210:211], v251 offset:30976
    ds_read_b64_tr_b16 v[212:213], v251 offset:31744
    ds_read_b64_tr_b16 v[214:215], v251 offset:32000
    ds_read_b64_tr_b16 v[216:217], v251 offset:32768
    ds_read_b64_tr_b16 v[218:219], v251 offset:33024
    v_mfma_f32_32x32x16_bf16 v[176:191], v[228:231], v[236:239], v[176:191]
    s_add_u32 m0, s97, 12288
    s_add_u32 s76, s76, s7
    s_nop 0
    buffer_load_dwordx4 v244, s[48:51], s76 offen offset:0 lds
    v_mfma_f32_32x32x16_bf16 v[192:207], v[232:235], v[236:239], v[192:207]
    buffer_load_dwordx4 v245, s[48:51], s76 offen offset:1024 lds
    s_waitcnt lgkmcnt(11)
    s_nop 0
    v_mfma_f32_32x32x16_bf16 v[160:175], v[16:19], v[28:31], v[160:175]
    ds_read_b128 v[236:239], v250 offset:16384
    ds_read_b64_tr_b16 v[224:225], v251 offset:33792
    ds_read_b64_tr_b16 v[226:227], v251 offset:34048
    ds_read_b64_tr_b16 v[228:229], v251 offset:34816
    s_waitcnt lgkmcnt(6)
    s_nop 0
    ds_read_b64_tr_b16 v[230:231], v251 offset:35072
    ds_read_b64_tr_b16 v[232:233], v251 offset:35840
    ds_read_b64_tr_b16 v[234:235], v251 offset:36096
    v_mfma_f32_32x32x16_bf16 v[176:191], v[20:23], v[28:31], v[176:191]
    buffer_load_dwordx4 v246, s[48:51], s76 offen offset:2048 lds
    v_mfma_f32_32x32x16_bf16 v[192:207], v[24:27], v[28:31], v[192:207]
    v_mfma_f32_32x32x16_bf16 v[160:175], v[208:211], v[220:223], v[160:175]
    s_waitcnt lgkmcnt(0)
    s_waitcnt vmcnt(16)
    s_barrier
    s_nop 0
    ds_read_b128 v[28:31], v247 offset:32768
    ds_read_b64_tr_b16 v[16:17], v251 offset:36864
    ds_read_b64_tr_b16 v[18:19], v251 offset:37120
    ds_read_b64_tr_b16 v[20:21], v251 offset:37888
    ds_read_b64_tr_b16 v[22:23], v251 offset:38144
    ds_read_b64_tr_b16 v[24:25], v251 offset:38912
    ds_read_b64_tr_b16 v[26:27], v251 offset:39168
    v_mfma_f32_32x32x16_bf16 v[176:191], v[212:215], v[220:223], v[176:191]
    s_add_u32 s76, s69, 5
    s_and_b32 s76, s76, 7
    s_lshl_b32 s77, s76, 7
    s_add_u32 s77, s77, s6
    s_add_u32 m0, s96, 16384
    s_mul_i32 s76, s76, 176128
    buffer_load_dwordx4 v240, s[44:47], s77 offen offset:0 lds
    v_mfma_f32_32x32x16_bf16 v[192:207], v[216:219], v[220:223], v[192:207]
    buffer_load_dwordx4 v241, s[44:47], s77 offen offset:1024 lds
    v_mfma_f32_32x32x16_bf16 v[160:175], v[224:227], v[236:239], v[160:175]
    ds_read_b128 v[220:223], v248 offset:32768
    ds_read_b64_tr_b16 v[208:209], v251 offset:39936
    ds_read_b64_tr_b16 v[210:211], v251 offset:40192
    ds_read_b64_tr_b16 v[212:213], v251 offset:40960
    ds_read_b64_tr_b16 v[214:215], v251 offset:41216
    ds_read_b64_tr_b16 v[216:217], v251 offset:41984
    ds_read_b64_tr_b16 v[218:219], v251 offset:42240
    v_mfma_f32_32x32x16_bf16 v[176:191], v[228:231], v[236:239], v[176:191]
    buffer_load_dwordx4 v242, s[44:47], s77 offen offset:2048 lds
    v_mfma_f32_32x32x16_bf16 v[192:207], v[232:235], v[236:239], v[192:207]
    buffer_load_dwordx4 v243, s[44:47], s77 offen offset:3072 lds
    s_waitcnt lgkmcnt(11)
    s_nop 0
    v_mfma_f32_32x32x16_bf16 v[160:175], v[16:19], v[28:31], v[160:175]
    ds_read_b128 v[236:239], v249 offset:32768
    ds_read_b64_tr_b16 v[224:225], v251 offset:43008
    ds_read_b64_tr_b16 v[226:227], v251 offset:43264
    ds_read_b64_tr_b16 v[228:229], v251 offset:44032
    s_waitcnt lgkmcnt(6)
    s_nop 0
    ds_read_b64_tr_b16 v[230:231], v251 offset:44288
    ds_read_b64_tr_b16 v[232:233], v251 offset:45056
    ds_read_b64_tr_b16 v[234:235], v251 offset:45312
    v_mfma_f32_32x32x16_bf16 v[176:191], v[20:23], v[28:31], v[176:191]
    s_add_u32 m0, s97, 24576
    s_add_u32 s76, s76, s7
    s_nop 0
    buffer_load_dwordx4 v244, s[48:51], s76 offen offset:0 lds
    v_mfma_f32_32x32x16_bf16 v[192:207], v[24:27], v[28:31], v[192:207]
    buffer_load_dwordx4 v245, s[48:51], s76 offen offset:1024 lds
    v_mfma_f32_32x32x16_bf16 v[160:175], v[208:211], v[220:223], v[160:175]
    ds_read_b128 v[28:31], v250 offset:32768
    ds_read_b64_tr_b16 v[16:17], v251 offset:46080
    ds_read_b64_tr_b16 v[18:19], v251 offset:46336
    ds_read_b64_tr_b16 v[20:21], v251 offset:47104
    ds_read_b64_tr_b16 v[22:23], v251 offset:47360
    ds_read_b64_tr_b16 v[24:25], v251 offset:48128
    s_waitcnt lgkmcnt(6)
    s_nop 0
    ds_read_b64_tr_b16 v[26:27], v251 offset:48384
    v_mfma_f32_32x32x16_bf16 v[176:191], v[212:215], v[220:223], v[176:191]
    buffer_load_dwordx4 v246, s[48:51], s76 offen offset:2048 lds
    v_mfma_f32_32x32x16_bf16 v[192:207], v[216:219], v[220:223], v[192:207]
    v_mfma_f32_32x32x16_bf16 v[160:175], v[224:227], v[236:239], v[160:175]
    s_waitcnt lgkmcnt(0)
    s_waitcnt vmcnt(16)
    s_barrier
    s_nop 0
    ds_read_b128 v[220:223], v247 offset:49152
    ds_read_b64_tr_b16 v[208:209], v251 offset:0
    ds_read_b64_tr_b16 v[210:211], v251 offset:256
    ds_read_b64_tr_b16 v[212:213], v251 offset:1024
    ds_read_b64_tr_b16 v[214:215], v251 offset:1280
    ds_read_b64_tr_b16 v[216:217], v251 offset:2048
    ds_read_b64_tr_b16 v[218:219], v251 offset:2304
    v_mfma_f32_32x32x16_bf16 v[176:191], v[228:231], v[236:239], v[176:191]
    s_add_u32 s76, s69, 6
    s_and_b32 s76, s76, 7
    s_lshl_b32 s77, s76, 7
    s_add_u32 s77, s77, s6
    s_add_u32 m0, s96, 32768
    s_mul_i32 s76, s76, 176128
    buffer_load_dwordx4 v240, s[44:47], s77 offen offset:0 lds
    v_mfma_f32_32x32x16_bf16 v[192:207], v[232:235], v[236:239], v[192:207]
    buffer_load_dwordx4 v241, s[44:47], s77 offen offset:1024 lds
    v_mfma_f32_32x32x16_bf16 v[160:175], v[16:19], v[28:31], v[160:175]
    ds_read_b128 v[236:239], v248 offset:49152
    ds_read_b64_tr_b16 v[224:225], v251 offset:3072
    ds_read_b64_tr_b16 v[226:227], v251 offset:3328
    ds_read_b64_tr_b16 v[228:229], v251 offset:4096
    ds_read_b64_tr_b16 v[230:231], v251 offset:4352
    ds_read_b64_tr_b16 v[232:233], v251 offset:5120
    ds_read_b64_tr_b16 v[234:235], v251 offset:5376
    v_mfma_f32_32x32x16_bf16 v[176:191], v[20:23], v[28:31], v[176:191]
    buffer_load_dwordx4 v242, s[44:47], s77 offen offset:2048 lds
    v_mfma_f32_32x32x16_bf16 v[192:207], v[24:27], v[28:31], v[192:207]
    buffer_load_dwordx4 v243, s[44:47], s77 offen offset:3072 lds
    s_waitcnt lgkmcnt(11)
    s_nop 0
    v_mfma_f32_32x32x16_bf16 v[160:175], v[208:211], v[220:223], v[160:175]
    ds_read_b128 v[28:31], v249 offset:49152
    ds_read_b64_tr_b16 v[16:17], v251 offset:6144
    ds_read_b64_tr_b16 v[18:19], v251 offset:6400
    ds_read_b64_tr_b16 v[20:21], v251 offset:7168
    s_waitcnt lgkmcnt(6)
    s_nop 0
    ds_read_b64_tr_b16 v[22:23], v251 offset:7424
    ds_read_b64_tr_b16 v[24:25], v251 offset:8192
    ds_read_b64_tr_b16 v[26:27], v251 offset:8448
    v_mfma_f32_32x32x16_bf16 v[176:191], v[212:215], v[220:223], v[176:191]
    s_add_u32 m0, s97, 36864
    s_add_u32 s76, s76, s7
    s_nop 0
    buffer_load_dwordx4 v244, s[48:51], s76 offen offset:0 lds
    v_mfma_f32_32x32x16_bf16 v[192:207], v[216:219], v[220:223], v[192:207]
    buffer_load_dwordx4 v245, s[48:51], s76 offen offset:1024 lds
    v_mfma_f32_32x32x16_bf16 v[160:175], v[224:227], v[236:239], v[160:175]
    ds_read_b128 v[220:223], v250 offset:49152
    ds_read_b64_tr_b16 v[208:209], v251 offset:9216
    ds_read_b64_tr_b16 v[210:211], v251 offset:9472
    ds_read_b64_tr_b16 v[212:213], v251 offset:10240
    ds_read_b64_tr_b16 v[214:215], v251 offset:10496
    ds_read_b64_tr_b16 v[216:217], v251 offset:11264
    s_waitcnt lgkmcnt(6)
    s_nop 0
    ds_read_b64_tr_b16 v[218:219], v251 offset:11520
    v_mfma_f32_32x32x16_bf16 v[176:191], v[228:231], v[236:239], v[176:191]
    buffer_load_dwordx4 v246, s[48:51], s76 offen offset:2048 lds
    v_mfma_f32_32x32x16_bf16 v[192:207], v[232:235], v[236:239], v[192:207]
    v_mfma_f32_32x32x16_bf16 v[160:175], v[16:19], v[28:31], v[160:175]
    s_waitcnt lgkmcnt(0)
    s_waitcnt vmcnt(14)
    s_barrier
    s_nop 0
    ds_read_b128 v[236:239], v247 offset:0
    ds_read_b64_tr_b16 v[224:225], v251 offset:12288
    ds_read_b64_tr_b16 v[226:227], v251 offset:12544
    ds_read_b64_tr_b16 v[228:229], v251 offset:13312
    ds_read_b64_tr_b16 v[230:231], v251 offset:13568
    ds_read_b64_tr_b16 v[232:233], v251 offset:14336
    ds_read_b64_tr_b16 v[234:235], v251 offset:14592
    v_mfma_f32_32x32x16_bf16 v[176:191], v[20:23], v[28:31], v[176:191]
    s_add_u32 s76, s69, 7
    s_and_b32 s76, s76, 7
    s_lshl_b32 s77, s76, 7
    s_add_u32 s77, s77, s6
    s_add_u32 m0, s96, 49152
    s_mul_i32 s76, s76, 176128
    buffer_load_dwordx4 v240, s[44:47], s77 offen offset:0 lds
    v_mfma_f32_32x32x16_bf16 v[192:207], v[24:27], v[28:31], v[192:207]
    buffer_load_dwordx4 v241, s[44:47], s77 offen offset:1024 lds
    v_mfma_f32_32x32x16_bf16 v[160:175], v[208:211], v[220:223], v[160:175]
    ds_read_b128 v[28:31], v248 offset:0
    ds_read_b64_tr_b16 v[16:17], v251 offset:15360
    ds_read_b64_tr_b16 v[18:19], v251 offset:15616
    ds_read_b64_tr_b16 v[20:21], v251 offset:16384
    ds_read_b64_tr_b16 v[22:23], v251 offset:16640
    ds_read_b64_tr_b16 v[24:25], v251 offset:17408
    ds_read_b64_tr_b16 v[26:27], v251 offset:17664
    v_mfma_f32_32x32x16_bf16 v[176:191], v[212:215], v[220:223], v[176:191]
    buffer_load_dwordx4 v242, s[44:47], s77 offen offset:2048 lds
    v_mfma_f32_32x32x16_bf16 v[192:207], v[216:219], v[220:223], v[192:207]
    buffer_load_dwordx4 v243, s[44:47], s77 offen offset:3072 lds
    s_waitcnt lgkmcnt(11)
    s_nop 0
    v_mfma_f32_32x32x16_bf16 v[160:175], v[224:227], v[236:239], v[160:175]
    ds_read_b128 v[220:223], v249 offset:0
    ds_read_b64_tr_b16 v[208:209], v251 offset:18432
    ds_read_b64_tr_b16 v[210:211], v251 offset:18688
    ds_read_b64_tr_b16 v[212:213], v251 offset:19456
    s_waitcnt lgkmcnt(6)
    s_nop 0
    ds_read_b64_tr_b16 v[214:215], v251 offset:19712
    ds_read_b64_tr_b16 v[216:217], v251 offset:20480
    ds_read_b64_tr_b16 v[218:219], v251 offset:20736
    v_mfma_f32_32x32x16_bf16 v[176:191], v[228:231], v[236:239], v[176:191]
    s_add_u32 m0, s97, 0
    s_add_u32 s76, s76, s7
    buffer_load_dwordx4 v244, s[48:51], s76 offen offset:0 lds
    v_mfma_f32_32x32x16_bf16 v[192:207], v[232:235], v[236:239], v[192:207]
    buffer_load_dwordx4 v245, s[48:51], s76 offen offset:1024 lds
    v_mfma_f32_32x32x16_bf16 v[160:175], v[16:19], v[28:31], v[160:175]
    ds_read_b128 v[236:239], v250 offset:0
    ds_read_b64_tr_b16 v[224:225], v251 offset:21504
    ds_read_b64_tr_b16 v[226:227], v251 offset:21760
    ds_read_b64_tr_b16 v[228:229], v251 offset:22528
    ds_read_b64_tr_b16 v[230:231], v251 offset:22784
    ds_read_b64_tr_b16 v[232:233], v251 offset:23552
    s_waitcnt lgkmcnt(6)
    s_nop 0
    ds_read_b64_tr_b16 v[234:235], v251 offset:23808
    v_mfma_f32_32x32x16_bf16 v[176:191], v[20:23], v[28:31], v[176:191]
    buffer_load_dwordx4 v246, s[48:51], s76 offen offset:2048 lds
    v_mfma_f32_32x32x16_bf16 v[192:207], v[24:27], v[28:31], v[192:207]
    v_mfma_f32_32x32x16_bf16 v[160:175], v[208:211], v[220:223], v[160:175]
    s_waitcnt lgkmcnt(0)
    s_waitcnt vmcnt(14)
    s_barrier
    s_nop 0
    ds_read_b128 v[28:31], v247 offset:16384
    ds_read_b64_tr_b16 v[16:17], v251 offset:24576
    ds_read_b64_tr_b16 v[18:19], v251 offset:24832
    ds_read_b64_tr_b16 v[20:21], v251 offset:25600
    ds_read_b64_tr_b16 v[22:23], v251 offset:25856
    ds_read_b64_tr_b16 v[24:25], v251 offset:26624
    ds_read_b64_tr_b16 v[26:27], v251 offset:26880
    v_mfma_f32_32x32x16_bf16 v[176:191], v[212:215], v[220:223], v[176:191]
    s_add_u32 m0, s97, 12288
    s_add_u32 s76, s98, 0
    s_nop 0
    buffer_load_dwordx4 v252, s[52:55], s76 offen lds
    v_mfma_f32_32x32x16_bf16 v[192:207], v[216:219], v[220:223], v[192:207]
    s_add_u32 m0, s97, 13312
    s_add_u32 s76, s98, 8192
    buffer_load_dwordx4 v252, s[52:55], s76 offen lds
    v_mfma_f32_32x32x16_bf16 v[160:175], v[224:227], v[236:239], v[160:175]
    ds_read_b128 v[220:223], v248 offset:16384
    ds_read_b64_tr_b16 v[208:209], v251 offset:27648
    ds_read_b64_tr_b16 v[210:211], v251 offset:27904
    ds_read_b64_tr_b16 v[212:213], v251 offset:28672
    ds_read_b64_tr_b16 v[214:215], v251 offset:28928
    ds_read_b64_tr_b16 v[216:217], v251 offset:29696
    ds_read_b64_tr_b16 v[218:219], v251 offset:29952
    v_mfma_f32_32x32x16_bf16 v[176:191], v[228:231], v[236:239], v[176:191]
    s_add_u32 m0, s97, 14336
    s_add_u32 s76, s98, 16384
    buffer_load_dwordx4 v252, s[52:55], s76 offen lds
    v_mfma_f32_32x32x16_bf16 v[192:207], v[232:235], v[236:239], v[192:207]
    s_add_u32 m0, s96, 0
    s_add_u32 s76, s98, 24576
    buffer_load_dwordx4 v252, s[52:55], s76 offen lds
    s_waitcnt lgkmcnt(11)
    v_mfma_f32_32x32x16_bf16 v[160:175], v[16:19], v[28:31], v[160:175]
    ds_read_b128 v[236:239], v249 offset:16384
    ds_read_b64_tr_b16 v[224:225], v251 offset:30720
    ds_read_b64_tr_b16 v[226:227], v251 offset:30976
    ds_read_b64_tr_b16 v[228:229], v251 offset:31744
    s_waitcnt lgkmcnt(6)
    s_nop 0
    ds_read_b64_tr_b16 v[230:231], v251 offset:32000
    ds_read_b64_tr_b16 v[232:233], v251 offset:32768
    ds_read_b64_tr_b16 v[234:235], v251 offset:33024
    v_mfma_f32_32x32x16_bf16 v[176:191], v[20:23], v[28:31], v[176:191]
    s_add_u32 m0, s96, 1024
    s_add_u32 s76, s98, 32768
    buffer_load_dwordx4 v2, s[52:55], s76 offen lds
    v_mfma_f32_32x32x16_bf16 v[192:207], v[24:27], v[28:31], v[192:207]
    s_add_u32 m0, s96, 2048
    s_add_u32 s76, s98, 40960
    buffer_load_dwordx4 v2, s[52:55], s76 offen lds
    v_mfma_f32_32x32x16_bf16 v[160:175], v[208:211], v[220:223], v[160:175]
    ds_read_b128 v[28:31], v250 offset:16384
    ds_read_b64_tr_b16 v[16:17], v251 offset:33792
    ds_read_b64_tr_b16 v[18:19], v251 offset:34048
    ds_read_b64_tr_b16 v[20:21], v251 offset:34816
    ds_read_b64_tr_b16 v[22:23], v251 offset:35072
    ds_read_b64_tr_b16 v[24:25], v251 offset:35840
    s_waitcnt lgkmcnt(6)
    s_nop 0
    ds_read_b64_tr_b16 v[26:27], v251 offset:36096
    v_mfma_f32_32x32x16_bf16 v[176:191], v[212:215], v[220:223], v[176:191]
    s_add_u32 m0, s96, 3072
    s_add_u32 s76, s98, 49152
    buffer_load_dwordx4 v2, s[52:55], s76 offen lds
    v_mfma_f32_32x32x16_bf16 v[192:207], v[216:219], v[220:223], v[192:207]
    v_mfma_f32_32x32x16_bf16 v[160:175], v[224:227], v[236:239], v[160:175]
    s_waitcnt lgkmcnt(0)
    s_waitcnt vmcnt(14)
    s_barrier
    s_nop 0
    ds_read_b128 v[220:223], v247 offset:32768
    ds_read_b64_tr_b16 v[208:209], v251 offset:36864
    ds_read_b64_tr_b16 v[210:211], v251 offset:37120
    ds_read_b64_tr_b16 v[212:213], v251 offset:37888
    ds_read_b64_tr_b16 v[214:215], v251 offset:38144
    ds_read_b64_tr_b16 v[216:217], v251 offset:38912
    ds_read_b64_tr_b16 v[218:219], v251 offset:39168
    v_mfma_f32_32x32x16_bf16 v[176:191], v[228:231], v[236:239], v[176:191]
    s_add_u32 m0, s97, 24576
    s_add_u32 s76, s98, 57344
    buffer_load_dwordx4 v2, s[52:55], s76 offen lds
    v_mfma_f32_32x32x16_bf16 v[192:207], v[232:235], v[236:239], v[192:207]
    s_add_u32 m0, s97, 25600
    s_add_u32 s76, s98, 65536
    buffer_load_dwordx4 v2, s[52:55], s76 offen lds
    v_mfma_f32_32x32x16_bf16 v[160:175], v[16:19], v[28:31], v[160:175]
    ds_read_b128 v[236:239], v248 offset:32768
    ds_read_b64_tr_b16 v[224:225], v251 offset:39936
    ds_read_b64_tr_b16 v[226:227], v251 offset:40192
    ds_read_b64_tr_b16 v[228:229], v251 offset:40960
    ds_read_b64_tr_b16 v[230:231], v251 offset:41216
    ds_read_b64_tr_b16 v[232:233], v251 offset:41984
    ds_read_b64_tr_b16 v[234:235], v251 offset:42240
    v_mfma_f32_32x32x16_bf16 v[176:191], v[20:23], v[28:31], v[176:191]
    s_add_u32 m0, s97, 26624
    s_add_u32 s76, s98, 73728
    buffer_load_dwordx4 v2, s[52:55], s76 offen lds
    v_mfma_f32_32x32x16_bf16 v[192:207], v[24:27], v[28:31], v[192:207]
    s_add_u32 m0, s96, 16384
    s_add_u32 s76, s98, 81920
    buffer_load_dwordx4 v2, s[52:55], s76 offen lds
    s_waitcnt lgkmcnt(11)
    s_nop 0
    v_mfma_f32_32x32x16_bf16 v[160:175], v[208:211], v[220:223], v[160:175]
    ds_read_b128 v[28:31], v249 offset:32768
    ds_read_b64_tr_b16 v[16:17], v251 offset:43008
    ds_read_b64_tr_b16 v[18:19], v251 offset:43264
    ds_read_b64_tr_b16 v[20:21], v251 offset:44032
    s_waitcnt lgkmcnt(6)
    s_nop 0
    ds_read_b64_tr_b16 v[22:23], v251 offset:44288
    ds_read_b64_tr_b16 v[24:25], v251 offset:45056
    ds_read_b64_tr_b16 v[26:27], v251 offset:45312
    v_mfma_f32_32x32x16_bf16 v[176:191], v[212:215], v[220:223], v[176:191]
    s_add_u32 m0, s96, 17408
    s_add_u32 s76, s98, 90112
    buffer_load_dwordx4 v2, s[52:55], s76 offen lds
    v_mfma_f32_32x32x16_bf16 v[192:207], v[216:219], v[220:223], v[192:207]
    s_add_u32 m0, s96, 18432
    s_add_u32 s76, s98, 98304
    buffer_load_dwordx4 v2, s[52:55], s76 offen lds
    v_mfma_f32_32x32x16_bf16 v[160:175], v[224:227], v[236:239], v[160:175]
    ds_read_b128 v[220:223], v250 offset:32768
    ds_read_b64_tr_b16 v[208:209], v251 offset:46080
    ds_read_b64_tr_b16 v[210:211], v251 offset:46336
    ds_read_b64_tr_b16 v[212:213], v251 offset:47104
    ds_read_b64_tr_b16 v[214:215], v251 offset:47360
    ds_read_b64_tr_b16 v[216:217], v251 offset:48128
    s_waitcnt lgkmcnt(6)
    s_nop 0
    ds_read_b64_tr_b16 v[218:219], v251 offset:48384
    v_mfma_f32_32x32x16_bf16 v[176:191], v[228:231], v[236:239], v[176:191]
    s_add_u32 m0, s96, 19456
    s_add_u32 s76, s98, 106496
    buffer_load_dwordx4 v2, s[52:55], s76 offen lds
    v_mfma_f32_32x32x16_bf16 v[192:207], v[232:235], v[236:239], v[192:207]
    v_mfma_f32_32x32x16_bf16 v[160:175], v[16:19], v[28:31], v[160:175]
    s_waitcnt lgkmcnt(0)
    s_waitcnt vmcnt(14)
    s_barrier
    s_nop 0
    ds_read_b128 v[236:239], v247 offset:49152
    ds_read_b64_tr_b16 v[224:225], v251 offset:0
    ds_read_b64_tr_b16 v[226:227], v251 offset:256
    ds_read_b64_tr_b16 v[228:229], v251 offset:1024
    ds_read_b64_tr_b16 v[230:231], v251 offset:1280
    ds_read_b64_tr_b16 v[232:233], v251 offset:2048
    ds_read_b64_tr_b16 v[234:235], v251 offset:2304
    v_mfma_f32_32x32x16_bf16 v[176:191], v[20:23], v[28:31], v[176:191]
    s_add_u32 m0, s97, 36864
    s_add_u32 s76, s98, 114688
    buffer_load_dwordx4 v2, s[52:55], s76 offen lds
    v_mfma_f32_32x32x16_bf16 v[192:207], v[24:27], v[28:31], v[192:207]
    s_add_u32 m0, s97, 37888
    s_add_u32 s76, s98, 122880
    buffer_load_dwordx4 v2, s[52:55], s76 offen lds
    v_mfma_f32_32x32x16_bf16 v[160:175], v[208:211], v[220:223], v[160:175]
    ds_read_b128 v[28:31], v248 offset:49152
    ds_read_b64_tr_b16 v[16:17], v251 offset:3072
    ds_read_b64_tr_b16 v[18:19], v251 offset:3328
    ds_read_b64_tr_b16 v[20:21], v251 offset:4096
    ds_read_b64_tr_b16 v[22:23], v251 offset:4352
    ds_read_b64_tr_b16 v[24:25], v251 offset:5120
    ds_read_b64_tr_b16 v[26:27], v251 offset:5376
    v_mfma_f32_32x32x16_bf16 v[176:191], v[212:215], v[220:223], v[176:191]
    s_add_u32 m0, s97, 38912
    s_add_u32 s76, s98, 131072
    buffer_load_dwordx4 v2, s[52:55], s76 offen lds
    v_mfma_f32_32x32x16_bf16 v[192:207], v[216:219], v[220:223], v[192:207]
    s_add_u32 m0, s96, 32768
    s_add_u32 s76, s98, 139264
    buffer_load_dwordx4 v2, s[52:55], s76 offen lds
    s_waitcnt lgkmcnt(11)
    s_nop 0
    v_mfma_f32_32x32x16_bf16 v[160:175], v[224:227], v[236:239], v[160:175]
    ds_read_b128 v[220:223], v249 offset:49152
    ds_read_b64_tr_b16 v[208:209], v251 offset:6144
    ds_read_b64_tr_b16 v[210:211], v251 offset:6400
    ds_read_b64_tr_b16 v[212:213], v251 offset:7168
    s_waitcnt lgkmcnt(6)
    s_nop 0
    ds_read_b64_tr_b16 v[214:215], v251 offset:7424
    ds_read_b64_tr_b16 v[216:217], v251 offset:8192
    ds_read_b64_tr_b16 v[218:219], v251 offset:8448
    v_mfma_f32_32x32x16_bf16 v[176:191], v[228:231], v[236:239], v[176:191]
    s_add_u32 m0, s96, 33792
    s_add_u32 s76, s98, 147456
    buffer_load_dwordx4 v2, s[52:55], s76 offen lds
    v_mfma_f32_32x32x16_bf16 v[192:207], v[232:235], v[236:239], v[192:207]
    s_add_u32 m0, s96, 34816
    s_add_u32 s76, s98, 155648
    buffer_load_dwordx4 v2, s[52:55], s76 offen lds
    v_mfma_f32_32x32x16_bf16 v[160:175], v[16:19], v[28:31], v[160:175]
    ds_read_b128 v[236:239], v250 offset:49152
    ds_read_b64_tr_b16 v[224:225], v251 offset:9216
    ds_read_b64_tr_b16 v[226:227], v251 offset:9472
    ds_read_b64_tr_b16 v[228:229], v251 offset:10240
    ds_read_b64_tr_b16 v[230:231], v251 offset:10496
    ds_read_b64_tr_b16 v[232:233], v251 offset:11264
    s_waitcnt lgkmcnt(6)
    s_nop 0
    ds_read_b64_tr_b16 v[234:235], v251 offset:11520
    v_mfma_f32_32x32x16_bf16 v[176:191], v[20:23], v[28:31], v[176:191]
    s_add_u32 m0, s96, 35840
    s_add_u32 s76, s98, 163840
    buffer_load_dwordx4 v2, s[52:55], s76 offen lds
    v_mfma_f32_32x32x16_bf16 v[192:207], v[24:27], v[28:31], v[192:207]
    v_mfma_f32_32x32x16_bf16 v[160:175], v[208:211], v[220:223], v[160:175]
    s_waitcnt lgkmcnt(0)
    s_barrier
    v_mfma_f32_32x32x16_bf16 v[160:175], v[224:227], v[236:239], v[160:175]
    v_mfma_f32_32x32x16_bf16 v[176:191], v[212:215], v[220:223], v[176:191]
    s_lshr_b32 s78, s64, 1
    s_lshl_b32 s77, s65, 1
    s_add_u32 s78, s78, s77
    s_mul_i32 s78, s78, 176128
    s_and_b32 s77, s64, 1
    s_lshl_b32 s77, s77, 10
    s_add_u32 s78, s78, s77
    s_mul_i32 s77, s66, 43
    s_lshr_b32 s77, s77, 4
    s_lshl_b32 s77, s77, 12
    s_add_u32 s78, s78, s77
    s_add_u32 s99, s78, 6291456
    v_or_b32_e64 v12, s3, v1
    v_mfma_f32_32x32x16_bf16 v[176:191], v[228:231], v[236:239], v[176:191]
    s_add_u32 m0, s97, 0
    s_nop 0
    s_add_u32 s76, s98, 172032
    buffer_load_dwordx4 v2, s[52:55], s76 offen lds
    s_add_u32 m0, s97, 1024
    s_add_u32 s76, s98, 180224
    buffer_load_dwordx4 v2, s[52:55], s76 offen lds
    v_mfma_f32_32x32x16_bf16 v[192:207], v[216:219], v[220:223], v[192:207]
    v_mul_f32 v160, v160, |v160|
    v_mul_f32 v161, v161, |v161|
    v_mul_f32 v162, v162, |v162|
    v_mul_f32 v163, v163, |v163|
    v_mul_f32 v164, v164, |v164|
    s_add_u32 m0, s97, 2048
    s_add_u32 s76, s98, 188416
    buffer_load_dwordx4 v2, s[52:55], s76 offen lds
    v_mul_f32 v165, v165, |v165|
    v_mfma_f32_32x32x16_bf16 v[192:207], v[232:235], v[236:239], v[192:207]
    v_mul_f32 v166, v166, |v166|
    v_mul_f32 v167, v167, |v167|
    v_cvt_pk_bf16_f32 v32, v160, v161
    v_cvt_pk_bf16_f32 v33, v162, v163
    v_cvt_pk_bf16_f32 v34, v164, v165
    v_cvt_pk_bf16_f32 v35, v166, v167
    v_pk_max_i16 v32, v32, 0
    v_pk_max_i16 v33, v33, 0
    v_pk_max_i16 v34, v34, 0
    v_pk_max_i16 v35, v35, 0
    v_xor_b32_e64 v32, v8, v32
    v_mul_f32 v168, v168, |v168|
    v_mul_f32 v169, v169, |v169|
    v_mul_f32 v170, v170, |v170|
    v_mul_f32 v171, v171, |v171|
    v_mul_f32 v172, v172, |v172|
    v_mul_f32 v173, v173, |v173|
    v_mul_f32 v174, v174, |v174|
    v_mul_f32 v175, v175, |v175|
    v_cvt_pk_bf16_f32 v36, v168, v169
    v_cvt_pk_bf16_f32 v37, v170, v171
    v_cvt_pk_bf16_f32 v38, v172, v173
    v_cvt_pk_bf16_f32 v39, v174, v175
    v_pk_max_i16 v36, v36, 0
    v_pk_max_i16 v37, v37, 0
    v_pk_max_i16 v38, v38, 0
    v_pk_max_i16 v39, v39, 0
    v_xor_b32_e64 v36, v8, v36
    buffer_store_dwordx4 v[32:35], v1, s[56:59], s99 offen offset:0 sc1
    buffer_store_dwordx4 v[36:39], v1, s[56:59], s99 offen offset:2048 sc1
    s_add_u32 s99, s99, 4096
    v_mul_f32 v176, v176, |v176|
    v_mul_f32 v177, v177, |v177|
    v_mul_f32 v178, v178, |v178|
    v_mul_f32 v179, v179, |v179|
    v_mul_f32 v180, v180, |v180|
    v_mul_f32 v181, v181, |v181|
    v_mul_f32 v182, v182, |v182|
    v_mul_f32 v183, v183, |v183|
    v_cvt_pk_bf16_f32 v40, v176, v177
    v_cvt_pk_bf16_f32 v41, v178, v179
    v_cvt_pk_bf16_f32 v42, v180, v181
    v_cvt_pk_bf16_f32 v43, v182, v183
    v_pk_max_i16 v40, v40, 0
    v_pk_max_i16 v41, v41, 0
    v_pk_max_i16 v42, v42, 0
    v_pk_max_i16 v43, v43, 0
    v_xor_b32_e64 v40, v8, v40
    v_mul_f32 v184, v184, |v184|
    v_mul_f32 v185, v185, |v185|
    v_mul_f32 v186, v186, |v186|
    v_mul_f32 v187, v187, |v187|
    v_mul_f32 v188, v188, |v188|
    v_mul_f32 v189, v189, |v189|
    v_mul_f32 v190, v190, |v190|
    v_mul_f32 v191, v191, |v191|
    v_cvt_pk_bf16_f32 v44, v184, v185
    v_cvt_pk_bf16_f32 v45, v186, v187
    v_cvt_pk_bf16_f32 v46, v188, v189
    v_cvt_pk_bf16_f32 v47, v190, v191
    v_pk_max_i16 v44, v44, 0
    v_pk_max_i16 v45, v45, 0
    v_pk_max_i16 v46, v46, 0
    v_pk_max_i16 v47, v47, 0
    v_xor_b32_e64 v44, v8, v44
    buffer_store_dwordx4 v[40:43], v1, s[56:59], s99 offen offset:0 sc1
    buffer_store_dwordx4 v[44:47], v1, s[56:59], s99 offen offset:2048 sc1
    s_add_u32 s99, s99, 4096
    v_mul_f32 v192, v192, |v192|
    v_mul_f32 v193, v193, |v193|
    v_mul_f32 v194, v194, |v194|
    v_mul_f32 v195, v195, |v195|
    v_mul_f32 v196, v196, |v196|
    v_mul_f32 v197, v197, |v197|
    v_mul_f32 v198, v198, |v198|
    v_mul_f32 v199, v199, |v199|
    v_cvt_pk_bf16_f32 v48, v192, v193
    v_cvt_pk_bf16_f32 v49, v194, v195
    v_cvt_pk_bf16_f32 v50, v196, v197
    v_cvt_pk_bf16_f32 v51, v198, v199
    v_pk_max_i16 v48, v48, 0
    v_pk_max_i16 v49, v49, 0
    v_pk_max_i16 v50, v50, 0
    v_pk_max_i16 v51, v51, 0
    v_xor_b32_e64 v48, v8, v48
    v_mul_f32 v200, v200, |v200|
    v_mul_f32 v201, v201, |v201|
    v_mul_f32 v202, v202, |v202|
    v_mul_f32 v203, v203, |v203|
    v_mul_f32 v204, v204, |v204|
    v_mul_f32 v205, v205, |v205|
    v_mul_f32 v206, v206, |v206|
    v_mul_f32 v207, v207, |v207|
    v_cvt_pk_bf16_f32 v52, v200, v201
    v_cvt_pk_bf16_f32 v53, v202, v203
    v_cvt_pk_bf16_f32 v54, v204, v205
    v_cvt_pk_bf16_f32 v55, v206, v207
    v_pk_max_i16 v52, v52, 0
    v_pk_max_i16 v53, v53, 0
    v_pk_max_i16 v54, v54, 0
    v_pk_max_i16 v55, v55, 0
    v_xor_b32_e64 v52, v8, v52
    buffer_store_dwordx4 v[48:51], v12, s[56:59], s99 offen offset:0 sc1
    buffer_store_dwordx4 v[52:55], v12, s[56:59], s99 offen offset:2048 sc1
    s_mul_i32 s77, s64, 22
    s_min_u32 s77, s77, 64
    s_mul_i32 s99, s67, 86
    s_add_u32 s99, s99, s77
    s_lshl_b32 s99, s99, 11
    s_add_u32 s99, s99, 6291456
    s_add_u32 m0, s96, 49152
    s_add_u32 s76, s98, 196608
    buffer_load_dwordx4 v2, s[52:55], s76 offen lds
    s_add_u32 m0, s96, 50176
    s_add_u32 s76, s98, 204800
    buffer_load_dwordx4 v2, s[52:55], s76 offen lds
    s_add_u32 m0, s96, 51200
    s_add_u32 s76, s98, 212992
    buffer_load_dwordx4 v2, s[52:55], s76 offen lds
    s_add_u32 m0, s96, 52224
    s_add_u32 s76, s98, 221184
    buffer_load_dwordx4 v2, s[52:55], s76 offen lds
    s_waitcnt vmcnt(32)
    s_nop 0
    ds_read_b64_tr_b16 v[80:81], v5 offset:12288
    ds_read_b64_tr_b16 v[82:83], v5 offset:13312
    ds_read_b64_tr_b16 v[84:85], v6 offset:12288
    ds_read_b64_tr_b16 v[86:87], v6 offset:13312
    s_waitcnt vmcnt(30)
    s_nop 0
    ds_read_b64_tr_b16 v[88:89], v5 offset:14336
    ds_read_b64_tr_b16 v[90:91], v3 offset:0
    ds_read_b64_tr_b16 v[92:93], v6 offset:14336
    ds_read_b64_tr_b16 v[94:95], v4 offset:0
    s_waitcnt vmcnt(28)
    s_nop 0
    ds_read_b64_tr_b16 v[96:97], v3 offset:1024
    ds_read_b64_tr_b16 v[98:99], v3 offset:2048
    ds_read_b64_tr_b16 v[100:101], v4 offset:1024
    ds_read_b64_tr_b16 v[102:103], v4 offset:2048
    s_waitcnt vmcnt(26)
    s_waitcnt lgkmcnt(8)
    ds_read_b64_tr_b16 v[104:105], v3 offset:3072
    ds_read_b64_tr_b16 v[106:107], v5 offset:24576
    ds_read_b64_tr_b16 v[108:109], v4 offset:3072
    ds_read_b64_tr_b16 v[110:111], v6 offset:24576
    s_waitcnt vmcnt(24)
    s_waitcnt lgkmcnt(8)
    ds_read_b64_tr_b16 v[112:113], v5 offset:25600
    ds_read_b64_tr_b16 v[114:115], v5 offset:26624
    ds_read_b64_tr_b16 v[116:117], v6 offset:25600
    ds_read_b64_tr_b16 v[118:119], v6 offset:26624
    s_waitcnt vmcnt(22)
    s_waitcnt lgkmcnt(8)
    ds_read_b64_tr_b16 v[120:121], v3 offset:16384
    ds_read_b64_tr_b16 v[122:123], v3 offset:17408
    ds_read_b64_tr_b16 v[124:125], v4 offset:16384
    ds_read_b64_tr_b16 v[126:127], v4 offset:17408
    s_waitcnt vmcnt(20)
    s_waitcnt lgkmcnt(8)
    ds_read_b64_tr_b16 v[128:129], v3 offset:18432
    ds_read_b64_tr_b16 v[130:131], v3 offset:19456
    ds_read_b64_tr_b16 v[132:133], v4 offset:18432
    ds_read_b64_tr_b16 v[134:135], v4 offset:19456
    s_waitcnt vmcnt(18)
    s_waitcnt lgkmcnt(8)
    ds_read_b64_tr_b16 v[136:137], v5 offset:36864
    ds_read_b64_tr_b16 v[138:139], v5 offset:37888
    ds_read_b64_tr_b16 v[140:141], v6 offset:36864
    ds_read_b64_tr_b16 v[142:143], v6 offset:37888
    s_add_u32 m0, s97, 12288
    s_add_u32 s76, s98, 229376
    buffer_load_dwordx4 v2, s[52:55], s76 offen lds
    s_add_u32 m0, s97, 13312
    s_add_u32 s76, s98, 237568
    buffer_load_dwordx4 v2, s[52:55], s76 offen lds
    s_add_u32 m0, s97, 14336
    s_add_u32 s76, s98, 245760
    buffer_load_dwordx4 v2, s[52:55], s76 offen lds
    s_add_u32 m0, s96, 0
    s_nop 0
    s_add_u32 s76, s98, 253952
    buffer_load_dwordx4 v2, s[52:55], s76 offen lds
    s_add_u32 m0, s96, 1024
    s_add_u32 s76, s98, 262144
    buffer_load_dwordx4 v2, s[52:55], s76 offen lds
    s_add_u32 m0, s96, 2048
    s_add_u32 s76, s98, 270336
    buffer_load_dwordx4 v2, s[52:55], s76 offen lds
    s_add_u32 m0, s96, 3072
    s_add_u32 s76, s98, 278528
    buffer_load_dwordx4 v2, s[52:55], s76 offen lds
    s_add_u32 m0, s97, 24576
    s_add_u32 s76, s98, 286720
    buffer_load_dwordx4 v2, s[52:55], s76 offen lds
    s_add_u32 m0, s97, 25600
    s_add_u32 s76, s98, 294912
    buffer_load_dwordx4 v2, s[52:55], s76 offen lds
    s_add_u32 m0, s97, 26624
    s_add_u32 s76, s98, 303104
    buffer_load_dwordx4 v2, s[52:55], s76 offen lds
    s_waitcnt lgkmcnt(8)
    s_nop 0
    s_add_u32 m0, s96, 16384
    s_add_u32 s76, s98, 311296
    buffer_load_dwordx4 v2, s[52:55], s76 offen lds
    s_add_u32 m0, s96, 17408
    s_add_u32 s76, s98, 319488
    buffer_load_dwordx4 v2, s[52:55], s76 offen lds
    s_waitcnt lgkmcnt(4)
    s_nop 0
    s_add_u32 m0, s96, 18432
    s_add_u32 s76, s98, 327680
    buffer_load_dwordx4 v2, s[52:55], s76 offen lds
    s_add_u32 m0, s96, 19456
    s_add_u32 s76, s98, 335872
    buffer_load_dwordx4 v2, s[52:55], s76 offen lds
    s_waitcnt lgkmcnt(0)
    s_nop 0
    s_add_u32 m0, s97, 36864
    s_add_u32 s76, s98, 344064
    buffer_load_dwordx4 v2, s[52:55], s76 offen lds
    s_add_u32 m0, s97, 37888
    s_add_u32 s76, s98, 352256
    buffer_load_dwordx4 v2, s[52:55], s76 offen lds
    v_and_b32 v15, 7, v0
    v_lshlrev_b32 v11, 4, v15
    v_add_u32 v12, 163072, v11
    ds_read_b128 v[244:247], v12
    v_lshrrev_b32 v13, 3, v0
    s_lshl_b32 s76, s64, 3
    v_add_u32 v14, s76, v13
    v_xor_b32 v2, v15, v13
    v_lshlrev_b32 v2, 4, v2
    v_and_b32 v12, 31, v14
    v_lshl_add_u32 v2, v12, 7, v2
    v_lshrrev_b32_e64 v12, 5, v14
    v_lshl_add_u32 v2, v12, 14, v2
    v_bfe_u32 v12, v14, 1, 3
    v_xor_b32 v12, v15, v12
    v_lshlrev_b32 v12, 4, v12
    v_lshl_add_u32 v12, v14, 7, v12
    v_add_u32 v7, 123392, v12
    v_lshlrev_b32_e64 v12, 2, v14
    v_add_u32 v10, 162688, v12
    v_lshl_add_u32 v11, v14, 10, v11
    s_lshl_b32 s76, s67, 16
    s_lshl_b32 s77, s68, 7
    s_add_u32 s76, s76, s77
    v_add_u32 v11, s76, v11
    s_waitcnt lgkmcnt(0)
    v_lshlrev_b32 v240, 16, v244
    v_and_b32 v241, 0xffff0000, v244
    v_lshlrev_b32_e64 v242, 16, v245
    v_and_b32 v243, 0xffff0000, v245
    v_lshlrev_b32_e64 v244, 16, v246
    v_and_b32 v245, 0xffff0000, v246
    v_lshlrev_b32_e64 v246, 16, v247
    v_and_b32 v247, 0xffff0000, v247
    v_and_b32 v13, 7, v0
    v_lshlrev_b32 v13, 4, v13
    v_and_b32_e64 v14, 31, v0
    v_lshl_add_u32 v14, v14, 7, v13
    v_lshrrev_b32_e64 v13, 5, v0
    v_lshl_add_u32 v14, v13, 3, v14
    v_add_u32_e64 v248, s96, v14
    s_lshl2_add_u32 s78, s64, 162992
    v_mov_b32 v15, s78
    v_xor_b32 v249, 16, v248
    v_xor_b32 v250, 32, v248
    v_xor_b32 v251, 48, v248
    v_xor_b32_e64 v252, 64, v248
    v_xor_b32 v253, 80, v248
    v_xor_b32 v254, 96, v248
    v_xor_b32 v255, 112, v248
    s_waitcnt vmcnt(20)
    s_mov_b32 s79, 0x80008000
    s_add_u32 s76, s99, 0
    buffer_load_dwordx4 v[160:163], v1, s[56:59], s76 offen offset:0 sc1
    buffer_load_dwordx4 v[164:167], v1, s[56:59], s76 offen offset:1024 sc1
    buffer_load_dwordx4 v[168:171], v1, s[56:59], s76 offen offset:2048 sc1
    buffer_load_dwordx4 v[172:175], v1, s[56:59], s76 offen offset:3072 sc1
    s_add_u32 s76, s99, 4096
    buffer_load_dwordx4 v[176:179], v1, s[56:59], s76 offen offset:0 sc1
    buffer_load_dwordx4 v[180:183], v1, s[56:59], s76 offen offset:1024 sc1
    buffer_load_dwordx4 v[184:187], v1, s[56:59], s76 offen offset:2048 sc1
    buffer_load_dwordx4 v[188:191], v1, s[56:59], s76 offen offset:3072 sc1
    s_add_u32 s76, s99, 8192
    buffer_load_dwordx4 v[192:195], v1, s[56:59], s76 offen offset:0 sc1
    buffer_load_dwordx4 v[196:199], v1, s[56:59], s76 offen offset:1024 sc1
    buffer_load_dwordx4 v[200:203], v1, s[56:59], s76 offen offset:2048 sc1
    buffer_load_dwordx4 v[204:207], v1, s[56:59], s76 offen offset:3072 sc1
    s_waitcnt vmcnt(8)
    v_xor_b32 v160, v8, v160
    v_xor_b32 v164, v8, v164
    v_xor_b32 v168, v8, v168
    v_xor_b32_e64 v172, v8, v172
    v_or3_b32 v12, v161, v162, v163
    v_or3_b32 v13, v165, v166, v167
    v_or3_b32 v12, v12, v169, v170
    v_or3_b32 v13, v13, v171, v173
    v_or3_b32 v12, v12, v174, v175
    v_or3_b32 v13, v13, v160, v164
    v_or3_b32 v12, v12, v168, v172
    v_bitop3_b32 v12, v12, v13, s79 bitop3:0xa8
    v_cmp_ne_u32 vcc, 0, v12
    s_cbranch_vccnz L_h0_slow
L_h0_ok:
    v_mfma_f32_32x32x16_bf16 v[16:31], v[80:83], v[160:163], 0
    v_mfma_f32_32x32x16_bf16 v[48:63], v[84:87], v[160:163], 0
    s_add_u32 s76, s99, 12288
    buffer_load_dwordx4 v[208:211], v1, s[56:59], s76 offen offset:0 sc1
    buffer_load_dwordx4 v[212:215], v1, s[56:59], s76 offen offset:1024 sc1
    v_mfma_f32_32x32x16_bf16 v[32:47], v[80:83], v[164:167], 0
    buffer_load_dwordx4 v[216:219], v1, s[56:59], s76 offen offset:2048 sc1
    buffer_load_dwordx4 v[220:223], v1, s[56:59], s76 offen offset:3072 sc1
    v_mfma_f32_32x32x16_bf16 v[64:79], v[84:87], v[164:167], 0
    s_waitcnt vmcnt(8)
    v_xor_b32 v176, v8, v176
    v_xor_b32 v180, v8, v180
    v_xor_b32 v184, v8, v184
    v_mfma_f32_32x32x16_bf16 v[16:31], v[88:91], v[168:171], v[16:31]
    v_xor_b32_e64 v188, v8, v188
    v_or3_b32 v12, v177, v178, v179
    v_or3_b32 v13, v181, v182, v183
    v_mfma_f32_32x32x16_bf16 v[48:63], v[92:95], v[168:171], v[48:63]
    v_or3_b32 v12, v12, v185, v186
    v_or3_b32 v13, v13, v187, v189
    v_or3_b32 v12, v12, v190, v191
    v_mfma_f32_32x32x16_bf16 v[32:47], v[88:91], v[172:175], v[32:47]
    v_or3_b32 v13, v13, v176, v180
    v_or3_b32 v12, v12, v184, v188
    v_bitop3_b32 v12, v12, v13, s79 bitop3:0xa8
    v_mfma_f32_32x32x16_bf16 v[64:79], v[92:95], v[172:175], v[64:79]
    v_cmp_ne_u32 vcc, 0, v12
    s_cbranch_vccnz L_h1_slow
L_h1_ok:
    v_mfma_f32_32x32x16_bf16 v[16:31], v[96:99], v[176:179], v[16:31]
    v_mfma_f32_32x32x16_bf16 v[48:63], v[100:103], v[176:179], v[48:63]
    s_add_u32 s76, s99, 16384
    buffer_load_dwordx4 v[224:227], v1, s[56:59], s76 offen offset:0 sc1
    buffer_load_dwordx4 v[228:231], v1, s[56:59], s76 offen offset:1024 sc1
    v_mfma_f32_32x32x16_bf16 v[32:47], v[96:99], v[180:183], v[32:47]
    buffer_load_dwordx4 v[232:235], v1, s[56:59], s76 offen offset:2048 sc1
    buffer_load_dwordx4 v[236:239], v1, s[56:59], s76 offen offset:3072 sc1
    v_mfma_f32_32x32x16_bf16 v[64:79], v[100:103], v[180:183], v[64:79]
    s_waitcnt vmcnt(8)
    v_xor_b32 v192, v8, v192
    v_xor_b32 v196, v8, v196
    v_xor_b32 v200, v8, v200
    v_mfma_f32_32x32x16_bf16 v[16:31], v[104:107], v[184:187], v[16:31]
    v_xor_b32_e64 v204, v8, v204
    v_or3_b32 v12, v193, v194, v195
    v_or3_b32 v13, v197, v198, v199
    v_mfma_f32_32x32x16_bf16 v[48:63], v[108:111], v[184:187], v[48:63]
    v_or3_b32 v12, v12, v201, v202
    v_or3_b32 v13, v13, v203, v205
    v_or3_b32 v12, v12, v206, v207
    v_mfma_f32_32x32x16_bf16 v[32:47], v[104:107], v[188:191], v[32:47]
    v_or3_b32 v13, v13, v192, v196
    v_or3_b32 v12, v12, v200, v204
    v_bitop3_b32 v12, v12, v13, s79 bitop3:0xa8
    v_mfma_f32_32x32x16_bf16 v[64:79], v[108:111], v[188:191], v[64:79]
    v_cmp_ne_u32 vcc, 0, v12
    s_cbranch_vccnz L_h2_slow
L_h2_ok:
    v_mfma_f32_32x32x16_bf16 v[16:31], v[112:115], v[192:195], v[16:31]
    v_mfma_f32_32x32x16_bf16 v[48:63], v[116:119], v[192:195], v[48:63]
    s_add_u32 s76, s99, 20480
    buffer_load_dwordx4 v[160:163], v1, s[56:59], s76 offen offset:0 sc1
    buffer_load_dwordx4 v[164:167], v1, s[56:59], s76 offen offset:1024 sc1
    v_mfma_f32_32x32x16_bf16 v[32:47], v[112:115], v[196:199], v[32:47]
    buffer_load_dwordx4 v[168:171], v1, s[56:59], s76 offen offset:2048 sc1
    buffer_load_dwordx4 v[172:175], v1, s[56:59], s76 offen offset:3072 sc1
    v_mfma_f32_32x32x16_bf16 v[64:79], v[116:119], v[196:199], v[64:79]
    s_waitcnt vmcnt(8)
    v_xor_b32 v208, v8, v208
    v_xor_b32 v212, v8, v212
    v_xor_b32 v216, v8, v216
    v_mfma_f32_32x32x16_bf16 v[16:31], v[120:123], v[200:203], v[16:31]
    v_xor_b32_e64 v220, v8, v220
    v_or3_b32 v12, v209, v210, v211
    v_or3_b32 v13, v213, v214, v215
    v_mfma_f32_32x32x16_bf16 v[48:63], v[124:127], v[200:203], v[48:63]
    v_or3_b32 v12, v12, v217, v218
    v_or3_b32 v13, v13, v219, v221
    v_or3_b32 v12, v12, v222, v223
    v_mfma_f32_32x32x16_bf16 v[32:47], v[120:123], v[204:207], v[32:47]
    v_or3_b32 v13, v13, v208, v212
    v_or3_b32 v12, v12, v216, v220
    v_bitop3_b32 v12, v12, v13, s79 bitop3:0xa8
    v_mfma_f32_32x32x16_bf16 v[64:79], v[124:127], v[204:207], v[64:79]
    v_cmp_ne_u32 vcc, 0, v12
    s_cbranch_vccnz L_h3_slow
L_h3_ok:
    v_mfma_f32_32x32x16_bf16 v[16:31], v[128:131], v[208:211], v[16:31]
    v_mfma_f32_32x32x16_bf16 v[48:63], v[132:135], v[208:211], v[48:63]
    s_add_u32 s76, s99, 24576
    buffer_load_dwordx4 v[176:179], v1, s[56:59], s76 offen offset:0 sc1
    buffer_load_dwordx4 v[180:183], v1, s[56:59], s76 offen offset:1024 sc1
    v_mfma_f32_32x32x16_bf16 v[32:47], v[128:131], v[212:215], v[32:47]
    buffer_load_dwordx4 v[184:187], v1, s[56:59], s76 offen offset:2048 sc1
    buffer_load_dwordx4 v[188:191], v1, s[56:59], s76 offen offset:3072 sc1
    v_mfma_f32_32x32x16_bf16 v[64:79], v[132:135], v[212:215], v[64:79]
    s_waitcnt vmcnt(8)
    v_xor_b32 v224, v8, v224
    v_xor_b32 v228, v8, v228
    v_xor_b32 v232, v8, v232
    v_xor_b32_e64 v236, v8, v236
    v_mfma_f32_32x32x16_bf16 v[16:31], v[136:139], v[216:219], v[16:31]
    ds_read_b64_tr_b16 v[144:145], v5 offset:38912
    ds_read_b64_tr_b16 v[146:147], v3 offset:32768
    ds_read_b64_tr_b16 v[148:149], v6 offset:38912
    ds_read_b64_tr_b16 v[150:151], v4 offset:32768
    v_mfma_f32_32x32x16_bf16 v[48:63], v[140:143], v[216:219], v[48:63]
    v_or3_b32 v12, v225, v226, v227
    v_or3_b32 v13, v229, v230, v231
    v_or3_b32 v12, v12, v233, v234
    v_or3_b32 v13, v13, v235, v237
    v_mfma_f32_32x32x16_bf16 v[32:47], v[136:139], v[220:223], v[32:47]
    v_or3_b32 v12, v12, v238, v239
    v_or3_b32 v13, v13, v224, v228
    v_or3_b32 v12, v12, v232, v236
    v_mfma_f32_32x32x16_bf16 v[64:79], v[140:143], v[220:223], v[64:79]
    v_bitop3_b32 v12, v12, v13, s79 bitop3:0xa8
    v_cmp_ne_u32_e64 vcc, 0, v12
    s_cbranch_vccnz L_h4_slow
L_h4_ok:
    s_waitcnt lgkmcnt(0)
    v_mfma_f32_32x32x16_bf16 v[16:31], v[144:147], v[224:227], v[16:31]
    ds_read_b64_tr_b16 v[152:153], v3 offset:33792
    ds_read_b64_tr_b16 v[154:155], v3 offset:34816
    ds_read_b64_tr_b16 v[156:157], v4 offset:33792
    ds_read_b64_tr_b16 v[158:159], v4 offset:34816
    v_mfma_f32_32x32x16_bf16 v[48:63], v[148:151], v[224:227], v[48:63]
    s_add_u32 s76, s99, 28672
    buffer_load_dwordx4 v[192:195], v1, s[56:59], s76 offen offset:0 sc1
    buffer_load_dwordx4 v[196:199], v1, s[56:59], s76 offen offset:1024 sc1
    v_mfma_f32_32x32x16_bf16 v[32:47], v[144:147], v[228:231], v[32:47]
    buffer_load_dwordx4 v[200:203], v1, s[56:59], s76 offen offset:2048 sc1
    buffer_load_dwordx4 v[204:207], v1, s[56:59], s76 offen offset:3072 sc1
    v_mfma_f32_32x32x16_bf16 v[64:79], v[148:151], v[228:231], v[64:79]
    s_waitcnt vmcnt(8)
    v_xor_b32 v160, v8, v160
    v_xor_b32 v164, v8, v164
    v_xor_b32 v168, v8, v168
    v_xor_b32 v172, v8, v172
    s_waitcnt lgkmcnt(0)
    v_mfma_f32_32x32x16_bf16 v[16:31], v[152:155], v[232:235], v[16:31]
    ds_read_b64_tr_b16 v[144:145], v3 offset:35840
    ds_read_b64_tr_b16 v[146:147], v5 offset:0
    ds_read_b64_tr_b16 v[148:149], v4 offset:35840
    ds_read_b64_tr_b16 v[150:151], v6 offset:0
    v_mfma_f32_32x32x16_bf16 v[48:63], v[156:159], v[232:235], v[48:63]
    v_or3_b32 v12, v161, v162, v163
    v_or3_b32 v13, v165, v166, v167
    v_or3_b32 v12, v12, v169, v170
    v_or3_b32 v13, v13, v171, v173
    v_mfma_f32_32x32x16_bf16 v[32:47], v[152:155], v[236:239], v[32:47]
    v_or3_b32 v12, v12, v174, v175
    v_or3_b32 v13, v13, v160, v164
    v_or3_b32 v12, v12, v168, v172
    v_mfma_f32_32x32x16_bf16 v[64:79], v[156:159], v[236:239], v[64:79]
    v_bitop3_b32 v12, v12, v13, s79 bitop3:0xa8
    v_cmp_ne_u32_e64 vcc, 0, v12
    s_cbranch_vccnz L_h5_slow
L_h5_ok:
    s_waitcnt lgkmcnt(0)
    v_mfma_f32_32x32x16_bf16 v[16:31], v[144:147], v[160:163], v[16:31]
    ds_read_b64_tr_b16 v[152:153], v5 offset:1024
    ds_read_b64_tr_b16 v[154:155], v5 offset:2048
    ds_read_b64_tr_b16 v[156:157], v6 offset:1024
    ds_read_b64_tr_b16 v[158:159], v6 offset:2048
    v_mfma_f32_32x32x16_bf16 v[48:63], v[148:151], v[160:163], v[48:63]
    s_add_u32 s76, s99, 32768
    buffer_load_dwordx4 v[208:211], v1, s[56:59], s76 offen offset:0 sc1
    buffer_load_dwordx4 v[212:215], v1, s[56:59], s76 offen offset:1024 sc1
    v_mfma_f32_32x32x16_bf16 v[32:47], v[144:147], v[164:167], v[32:47]
    buffer_load_dwordx4 v[216:219], v1, s[56:59], s76 offen offset:2048 sc1
    buffer_load_dwordx4 v[220:223], v1, s[56:59], s76 offen offset:3072 sc1
    v_mfma_f32_32x32x16_bf16 v[64:79], v[148:151], v[164:167], v[64:79]
    s_waitcnt vmcnt(8)
    v_xor_b32 v176, v8, v176
    v_xor_b32 v180, v8, v180
    v_xor_b32 v184, v8, v184
    v_xor_b32 v188, v8, v188
    s_waitcnt lgkmcnt(0)
    v_mfma_f32_32x32x16_bf16 v[16:31], v[152:155], v[168:171], v[16:31]
    ds_read_b64_tr_b16 v[144:145], v3 offset:49152
    ds_read_b64_tr_b16 v[146:147], v3 offset:50176
    ds_read_b64_tr_b16 v[148:149], v4 offset:49152
    ds_read_b64_tr_b16 v[150:151], v4 offset:50176
    v_mfma_f32_32x32x16_bf16 v[48:63], v[156:159], v[168:171], v[48:63]
    v_or3_b32 v12, v177, v178, v179
    v_or3_b32 v13, v181, v182, v183
    v_or3_b32 v12, v12, v185, v186
    v_or3_b32 v13, v13, v187, v189
    v_mfma_f32_32x32x16_bf16 v[32:47], v[152:155], v[172:175], v[32:47]
    v_or3_b32 v12, v12, v190, v191
    v_or3_b32 v13, v13, v176, v180
    v_or3_b32 v12, v12, v184, v188
    v_mfma_f32_32x32x16_bf16 v[64:79], v[156:159], v[172:175], v[64:79]
    v_bitop3_b32 v12, v12, v13, s79 bitop3:0xa8
    v_cmp_ne_u32_e64 vcc, 0, v12
    s_cbranch_vccnz L_h6_slow
L_h6_ok:
    s_waitcnt lgkmcnt(0)
    v_mfma_f32_32x32x16_bf16 v[16:31], v[144:147], v[176:179], v[16:31]
    ds_read_b64_tr_b16 v[152:153], v3 offset:51200
    ds_read_b64_tr_b16 v[154:155], v3 offset:52224
    ds_read_b64_tr_b16 v[156:157], v4 offset:51200
    ds_read_b64_tr_b16 v[158:159], v4 offset:52224
    v_mfma_f32_32x32x16_bf16 v[48:63], v[148:151], v[176:179], v[48:63]
    s_add_u32 s76, s99, 36864
    buffer_load_dwordx4 v[224:227], v1, s[56:59], s76 offen offset:0 sc1
    buffer_load_dwordx4 v[228:231], v1, s[56:59], s76 offen offset:1024 sc1
    v_mfma_f32_32x32x16_bf16 v[32:47], v[144:147], v[180:183], v[32:47]
    buffer_load_dwordx4 v[232:235], v1, s[56:59], s76 offen offset:2048 sc1
    buffer_load_dwordx4 v[236:239], v1, s[56:59], s76 offen offset:3072 sc1
    v_mfma_f32_32x32x16_bf16 v[64:79], v[148:151], v[180:183], v[64:79]
    s_waitcnt vmcnt(8)
    v_xor_b32 v192, v8, v192
    v_xor_b32 v196, v8, v196
    v_xor_b32 v200, v8, v200
    v_xor_b32 v204, v8, v204
    s_waitcnt lgkmcnt(0)
    v_mfma_f32_32x32x16_bf16 v[16:31], v[152:155], v[184:187], v[16:31]
    ds_read_b64_tr_b16 v[144:145], v5 offset:12288
    ds_read_b64_tr_b16 v[146:147], v5 offset:13312
    ds_read_b64_tr_b16 v[148:149], v6 offset:12288
    ds_read_b64_tr_b16 v[150:151], v6 offset:13312
    v_mfma_f32_32x32x16_bf16 v[48:63], v[156:159], v[184:187], v[48:63]
    v_or3_b32 v12, v193, v194, v195
    v_or3_b32 v13, v197, v198, v199
    v_or3_b32 v12, v12, v201, v202
    v_or3_b32 v13, v13, v203, v205
    v_mfma_f32_32x32x16_bf16 v[32:47], v[152:155], v[188:191], v[32:47]
    v_or3_b32 v12, v12, v206, v207
    v_or3_b32 v13, v13, v192, v196
    v_or3_b32 v12, v12, v200, v204
    v_mfma_f32_32x32x16_bf16 v[64:79], v[156:159], v[188:191], v[64:79]
    v_bitop3_b32 v12, v12, v13, s79 bitop3:0xa8
    v_cmp_ne_u32_e64 vcc, 0, v12
    s_cbranch_vccnz L_h7_slow
L_h7_ok:
    s_waitcnt lgkmcnt(0)
    v_mfma_f32_32x32x16_bf16 v[16:31], v[144:147], v[192:195], v[16:31]
    ds_read_b64_tr_b16 v[152:153], v5 offset:14336
    ds_read_b64_tr_b16 v[154:155], v3 offset:0
    ds_read_b64_tr_b16 v[156:157], v6 offset:14336
    ds_read_b64_tr_b16 v[158:159], v4 offset:0
    ds_write_b32 v15, v15
    v_mfma_f32_32x32x16_bf16 v[48:63], v[148:151], v[192:195], v[48:63]
    s_add_u32 s76, s99, 40960
    buffer_load_dwordx4 v[160:163], v1, s[56:59], s76 offen offset:0 sc1
    buffer_load_dwordx4 v[164:167], v1, s[56:59], s76 offen offset:1024 sc1
    v_mfma_f32_32x32x16_bf16 v[32:47], v[144:147], v[196:199], v[32:47]
    buffer_load_dwordx4 v[168:171], v1, s[56:59], s76 offen offset:2048 sc1
    buffer_load_dwordx4 v[172:175], v1, s[56:59], s76 offen offset:3072 sc1
    v_mfma_f32_32x32x16_bf16 v[64:79], v[148:151], v[196:199], v[64:79]
    s_waitcnt vmcnt(8)
    v_xor_b32 v208, v8, v208
    v_xor_b32 v212, v8, v212
    v_xor_b32 v216, v8, v216
    v_xor_b32 v220, v8, v220
    s_waitcnt lgkmcnt(1)
    v_mfma_f32_32x32x16_bf16 v[16:31], v[152:155], v[200:203], v[16:31]
    ds_read_b64_tr_b16 v[144:145], v3 offset:1024
    ds_read_b64_tr_b16 v[146:147], v3 offset:2048
    ds_read_b64_tr_b16 v[148:149], v4 offset:1024
    ds_read_b64_tr_b16 v[150:151], v4 offset:2048
    v_mfma_f32_32x32x16_bf16 v[48:63], v[156:159], v[200:203], v[48:63]
    v_or3_b32 v12, v209, v210, v211
    v_or3_b32 v13, v213, v214, v215
    v_or3_b32 v12, v12, v217, v218
    v_or3_b32 v13, v13, v219, v221
    v_mfma_f32_32x32x16_bf16 v[32:47], v[152:155], v[204:207], v[32:47]
    v_or3_b32 v12, v12, v222, v223
    v_or3_b32 v13, v13, v208, v212
    v_or3_b32 v12, v12, v216, v220
    v_mfma_f32_32x32x16_bf16 v[64:79], v[156:159], v[204:207], v[64:79]
    v_bitop3_b32 v12, v12, v13, s79 bitop3:0xa8
    v_cmp_ne_u32_e64 vcc, 0, v12
    s_cbranch_vccnz L_h8_slow
L_h8_ok:
    s_waitcnt lgkmcnt(0)
    v_mfma_f32_32x32x16_bf16 v[16:31], v[144:147], v[208:211], v[16:31]
    ds_read_b64_tr_b16 v[152:153], v3 offset:3072
    ds_read_b64_tr_b16 v[154:155], v5 offset:24576
    ds_read_b64_tr_b16 v[156:157], v4 offset:3072
    ds_read_b64_tr_b16 v[158:159], v6 offset:24576
    v_mfma_f32_32x32x16_bf16 v[48:63], v[148:151], v[208:211], v[48:63]
    v_mfma_f32_32x32x16_bf16 v[32:47], v[144:147], v[212:215], v[32:47]
    v_mfma_f32_32x32x16_bf16 v[64:79], v[148:151], v[212:215], v[64:79]
    s_waitcnt vmcnt(4)
    v_xor_b32 v224, v8, v224
    v_xor_b32 v228, v8, v228
    v_xor_b32 v232, v8, v232
    v_xor_b32 v236, v8, v236
    s_waitcnt lgkmcnt(0)
    v_mfma_f32_32x32x16_bf16 v[16:31], v[152:155], v[216:219], v[16:31]
    ds_read_b64_tr_b16 v[144:145], v5 offset:25600
    ds_read_b64_tr_b16 v[146:147], v5 offset:26624
    ds_read_b64_tr_b16 v[148:149], v6 offset:25600
    ds_read_b64_tr_b16 v[150:151], v6 offset:26624
    v_mfma_f32_32x32x16_bf16 v[48:63], v[156:159], v[216:219], v[48:63]
    v_or3_b32 v12, v225, v226, v227
    v_or3_b32 v13, v229, v230, v231
    v_or3_b32 v12, v12, v233, v234
    v_or3_b32 v13, v13, v235, v237
    v_mfma_f32_32x32x16_bf16 v[32:47], v[152:155], v[220:223], v[32:47]
    v_or3_b32 v12, v12, v238, v239
    v_or3_b32 v13, v13, v224, v228
    v_or3_b32 v12, v12, v232, v236
    v_mfma_f32_32x32x16_bf16 v[64:79], v[156:159], v[220:223], v[64:79]
    v_bitop3_b32 v12, v12, v13, s79 bitop3:0xa8
    v_cmp_ne_u32_e64 vcc, 0, v12
    s_cbranch_vccnz L_h9_slow
L_h9_ok:
    s_waitcnt lgkmcnt(0)
    v_mfma_f32_32x32x16_bf16 v[16:31], v[144:147], v[224:227], v[16:31]
    ds_read_b64_tr_b16 v[152:153], v3 offset:16384
    ds_read_b64_tr_b16 v[154:155], v3 offset:17408
    ds_read_b64_tr_b16 v[156:157], v4 offset:16384
    ds_read_b64_tr_b16 v[158:159], v4 offset:17408
    v_mfma_f32_32x32x16_bf16 v[48:63], v[148:151], v[224:227], v[48:63]
    ds_read_b64_tr_b16 v[80:81], v5 offset:36864
    ds_read_b64_tr_b16 v[82:83], v5 offset:37888
    ds_read_b64_tr_b16 v[84:85], v6 offset:36864
    ds_read_b64_tr_b16 v[86:87], v6 offset:37888
    v_mfma_f32_32x32x16_bf16 v[32:47], v[144:147], v[228:231], v[32:47]
    v_mfma_f32_32x32x16_bf16 v[64:79], v[148:151], v[228:231], v[64:79]
    s_waitcnt vmcnt(0)
    v_xor_b32 v160, v8, v160
    v_xor_b32 v164, v8, v164
    v_xor_b32 v168, v8, v168
    v_xor_b32 v172, v8, v172
    s_waitcnt lgkmcnt(4)
    v_mfma_f32_32x32x16_bf16 v[16:31], v[152:155], v[232:235], v[16:31]
    ds_read_b64_tr_b16 v[144:145], v3 offset:18432
    ds_read_b64_tr_b16 v[146:147], v3 offset:19456
    ds_read_b64_tr_b16 v[148:149], v4 offset:18432
    ds_read_b64_tr_b16 v[150:151], v4 offset:19456
    v_mfma_f32_32x32x16_bf16 v[48:63], v[156:159], v[232:235], v[48:63]
    v_or3_b32 v12, v161, v162, v163
    v_or3_b32 v13, v165, v166, v167
    v_or3_b32 v12, v12, v169, v170
    v_or3_b32 v13, v13, v171, v173
    v_mfma_f32_32x32x16_bf16 v[32:47], v[152:155], v[236:239], v[32:47]
    v_or3_b32 v12, v12, v174, v175
    v_or3_b32 v13, v13, v160, v164
    v_or3_b32 v12, v12, v168, v172
    v_mfma_f32_32x32x16_bf16 v[64:79], v[156:159], v[236:239], v[64:79]
    v_bitop3_b32 v12, v12, v13, s79 bitop3:0xa8
    v_cmp_ne_u32_e64 vcc, 0, v12
    s_cbranch_vccnz L_h10_slow
L_h10_ok:
    s_waitcnt lgkmcnt(0)
    v_mfma_f32_32x32x16_bf16 v[16:31], v[144:147], v[160:163], v[16:31]
    v_mfma_f32_32x32x16_bf16 v[16:31], v[80:83], v[168:171], v[16:31]
    v_mfma_f32_32x32x16_bf16 v[48:63], v[148:151], v[160:163], v[48:63]
    s_nop 7
    v_mfma_f32_32x32x16_bf16 v[48:63], v[84:87], v[168:171], v[48:63]
    s_nop 1
    v_cvt_pk_bf16_f32 v96, v16, v17
    v_cvt_pk_bf16_f32 v97, v18, v19
    v_cvt_pk_bf16_f32 v98, v20, v21
    v_cvt_pk_bf16_f32 v99, v22, v23
    v_cvt_pk_bf16_f32 v100, v24, v25
    v_cvt_pk_bf16_f32 v101, v26, v27
    v_mfma_f32_32x32x16_bf16 v[32:47], v[144:147], v[164:167], v[32:47]
    v_cvt_pk_bf16_f32 v102, v28, v29
    v_cvt_pk_bf16_f32 v103, v30, v31
    ds_write_b64 v248, v[96:97] offset:32768
    ds_write_b64 v249, v[98:99] offset:32768
    ds_write_b64 v250, v[100:101] offset:32768
    ds_write_b64 v251, v[102:103] offset:32768
    v_mfma_f32_32x32x16_bf16 v[32:47], v[80:83], v[172:175], v[32:47]
    v_cvt_pk_bf16_f32 v104, v48, v49
    v_cvt_pk_bf16_f32 v105, v50, v51
    v_cvt_pk_bf16_f32 v106, v52, v53
    v_cvt_pk_bf16_f32 v107, v54, v55
    v_cvt_pk_bf16_f32 v108, v56, v57
    v_cvt_pk_bf16_f32 v109, v58, v59
    v_mfma_f32_32x32x16_bf16 v[64:79], v[148:151], v[164:167], v[64:79]
    v_cvt_pk_bf16_f32 v110, v60, v61
    v_cvt_pk_bf16_f32 v111, v62, v63
    ds_write_b64 v252, v[104:105] offset:32768
    ds_write_b64 v253, v[106:107] offset:32768
    ds_write_b64 v254, v[108:109] offset:32768
    ds_write_b64 v255, v[110:111] offset:32768
    v_mfma_f32_32x32x16_bf16 v[64:79], v[84:87], v[172:175], v[64:79]
    v_cvt_pk_bf16_f32 v112, v32, v33
    v_cvt_pk_bf16_f32 v113, v34, v35
    v_cvt_pk_bf16_f32 v114, v36, v37
    v_cvt_pk_bf16_f32 v115, v38, v39
    v_cvt_pk_bf16_f32 v116, v40, v41
    v_cvt_pk_bf16_f32 v117, v42, v43
    v_cvt_pk_bf16_f32 v118, v44, v45
    v_cvt_pk_bf16_f32 v119, v46, v47
    ds_write_b64 v248, v[112:113] offset:49152
    ds_write_b64 v249, v[114:115] offset:49152
    ds_write_b64 v250, v[116:117] offset:49152
    ds_write_b64 v251, v[118:119] offset:49152
    v_cvt_pk_bf16_f32 v120, v64, v65
    v_cvt_pk_bf16_f32 v121, v66, v67
    v_cvt_pk_bf16_f32 v122, v68, v69
    v_cvt_pk_bf16_f32 v123, v70, v71
    v_cvt_pk_bf16_f32 v124, v72, v73
    v_cvt_pk_bf16_f32 v125, v74, v75
    v_cvt_pk_bf16_f32 v126, v76, v77
    v_cvt_pk_bf16_f32 v127, v78, v79
    ds_write_b64 v252, v[120:121] offset:49152
    ds_write_b64 v253, v[122:123] offset:49152
    ds_write_b64 v254, v[124:125] offset:49152
    ds_write_b64 v255, v[126:127] offset:49152
    s_waitcnt lgkmcnt(0)
    s_branch L_final
.p2align 6
L_C:
    s_sub_u32 s96, s64, 4
    s_lshr_b32 s97, s96, 1
    s_and_b32 s98, s96, 1
    s_lshl1_add_u32 s99, s3, s97
    s_and_b32 s76, s66, 1
    s_lshl1_add_u32 s67, s65, s76
    s_lshr_b32 s68, s66, 1
    v_lshlrev_b32 v3, 4, v0

    s_mul_i32 s76, s96, 8704
    s_cmp_eq_u32 s96, 3
    s_cselect_b32 s76, 65280, s76
    s_mov_b32 m0, s76
    v_and_b32 v37, 31, v0
    v_lshrrev_b32 v38, 5, v0
    s_mul_i32 s76, s97, 8704
    s_mul_i32 s77, s98, 4480
    s_add_u32 s76, s76, s77
    s_add_u32 s76, s76, 127472
    v_lshlrev_b32 v39, 4, v37
    v_sub_u32 v39, s76, v39
    v_lshlrev_b32 v40, 9, v38
    v_sub_u32_e64 v8, v39, v40
    v_subrev_u32 v8, 3072, v8
    v_lshl_add_u32 v9, v38, 10, v39
    v_subrev_u32 v9, 2560, v9
    v_lshl_add_u32 v11, v37, 2, s76
    s_mul_i32 s76, s96, 5120
    s_add_u32 s76, s76, 140800
    v_add_u32 v14, s76, v3

    v_mov_b32 v229, 0
    v_lshlrev_b32 v39, 3, v0
    v_sub_u32 v39, v14, v39
    ds_write_b64 v39, v[228:229] offset:32
    s_lshl_b32 s76, s97, 4
    s_add_u32 s76, s76, 163008
    v_mov_b32 v15, s76
    s_lshl_b32 s77, s98, 2
    v_add_u32_e64 v2, s77, v15
    s_mov_b32 s79, m0
    s_cmp_eq_u32 s96, 1
    s_cbranch_scc1 L_j1
    s_cmp_ge_u32 s96, 2
    s_cbranch_scc1 L_j2
    s_mov_b32 m0, 161280
    s_nop 0
    global_load_lds_dwordx4 v3, s[36:37]
    s_branch L_jx
L_j1:
    s_mov_b32 s60, s30
    s_mov_b32 s61, s31
    s_mov_b32 s62, 2752
    s_mov_b32 s63, 0x20000
    s_mov_b32 m0, 162304
    s_mul_i32 s76, s66, 172
    s_andn2_b32 s76, s76, 63
    buffer_load_dword v27, s[60:63], s76 offen lds
    s_mov_b32 m0, 163072
    s_lshl_b32 s76, s68, 7
    v_add_u32_e64 v29, s76, v27
    s_mov_b64 exec, 0xffffffff
    global_load_lds_dword v29, s[34:35]
    s_mov_b64 exec, -1
    s_branch L_jx
L_j2:
    s_and_b32 s76, s65, 3
    s_and_b32 s77, s66, 7
    s_lshl3_add_u32 s76, s76, s77
    s_mul_i32 s76, s76, 43
    s_mul_i32 s77, s98, 21
    s_add_u32 s76, s76, s77
    v_min_u32 v28, 21, v0
    v_add_u32 v28, s76, v28
    v_and_b32 v29, 3, v28
    v_lshrrev_b32 v28, 2, v28
    v_lshlrev_b32_e64 v29, 7, v29
    v_lshl_add_u32 v28, v28, 10, v29
    s_lshr_b32 s76, s65, 2
    s_mul_i32 s76, s76, 352256
    s_lshr_b32 s77, s66, 3
    s_lshl_b32 s77, s77, 9
    s_add_u32 s76, s76, s77
    v_add_u32_e64 v28, s76, v28
    global_load_dword v254, v28, s[32:33]
L_jx:
    s_mov_b32 m0, s79
    v_mov_b32 v24, 0x3fb8aa3b
    s_setprio 3
    s_waitcnt vmcnt(6)
    v_lshlrev_b32 v25, 16, v22
    v_mul_f32 v25, v25, v24
    v_exp_f32 v25, v25
    v_lshlrev_b32 v16, 16, v16
    v_lshlrev_b32 v17, 16, v17
    v_cvt_pk_bf16_f32 v25, v25, v25
    v_lshlrev_b32 v25, 16, v25
    v_mul_f32 v22, v25, v16
    v_mul_f32 v23, v25, v17
    v_mul_f32 v22, v22, v24
    v_mul_f32_e64 v23, 0.15915494, v23
    v_mul_f32 v40, 0x41000000, v22
    v_mul_f32 v41, 0x41000000, v23
    v_mul_f32 v44, 0x43800000, v22
    v_mul_f32 v45, 0x43800000, v23
    v_mul_f32 v48, 0x43780000, v22
    v_mul_f32 v49, 0x43780000, v23
    v_exp_f32 v40, v40
    v_fract_f32 v41, v41
    v_fract_f32 v45, v45
    v_fract_f32 v49, v49
    v_fract_f32 v23, v23
    v_cos_f32 v42, v41
    v_sin_f32 v43, v41
    v_exp_f32 v44, v44
    v_mul_f32 v66, v40, v42
    v_mul_f32 v67, v40, v43
    v_cos_f32 v46, v45
    v_sin_f32 v47, v45
    v_exp_f32 v22, v22
    v_mul_f32 v68, v44, v46
    v_mul_f32 v69, v44, v47
    v_cos_f32 v42, v23
    v_sin_f32 v43, v23
    v_exp_f32 v48, v48
    v_mul_f32 v64, v22, v42
    v_mul_f32 v65, v22, v43
    v_cos_f32 v46, v49
    v_sin_f32 v47, v49
    v_mul_f32 v86, v48, v46
    v_mul_f32 v87, v48, v47
    s_waitcnt vmcnt(2)
    v_lshlrev_b32 v18, 16, v18
    v_lshlrev_b32 v19, 16, v19
    v_lshlrev_b32 v20, 16, v20
    v_lshlrev_b32 v21, 16, v21
    v_mul_f32 v18, v25, v18
    v_mul_f32 v19, v25, v19
    v_mul_f32 v40, v20, v18
    v_mul_f32_e64 v41, v20, v19
    v_fma_f32 v70, -v21, v19, v40
    v_fma_f32 v71, v21, v18, v41
    v_pk_mul_f32 v[52:53], v[64:65], v[64:65] op_sel:[0,0] op_sel_hi:[1,0]
    v_pk_mul_f32 v[54:55], v[70:71], v[64:65] op_sel:[0,0] op_sel_hi:[1,0]
    v_pk_mul_f32 v[56:57], v[70:71], v[68:69] op_sel:[0,0] op_sel_hi:[1,0]
    v_pk_mul_f32 v[58:59], v[68:69], v[68:69] op_sel:[0,0] op_sel_hi:[1,0]
    v_pk_fma_f32 v[52:53], v[64:65], v[64:65], v[52:53] op_sel:[1,1,0] op_sel_hi:[0,1,1] neg_lo:[1,0,0]
    v_pk_fma_f32 v[54:55], v[70:71], v[64:65], v[54:55] op_sel:[1,1,0] op_sel_hi:[0,1,1] neg_lo:[1,0,0]
    v_pk_fma_f32 v[56:57], v[70:71], v[68:69], v[56:57] op_sel:[1,1,0] op_sel_hi:[0,1,1] neg_lo:[1,0,0]
    v_pk_fma_f32 v[58:59], v[68:69], v[68:69], v[58:59] op_sel:[1,1,0] op_sel_hi:[0,1,1] neg_lo:[1,0,0]
    v_cvt_pk_bf16_f32 v44, v70, -v71
    ds_write_addtid_b32 v44 offset:49408
    v_pk_mul_f32 v[60:61], v[70:71], v[52:53] op_sel:[0,0] op_sel_hi:[1,0]
    v_pk_mul_f32 v[62:63], v[54:55], v[52:53] op_sel:[0,0] op_sel_hi:[1,0]
    v_pk_mul_f32 v[72:73], v[70:71], v[58:59] op_sel:[0,0] op_sel_hi:[1,0]
    v_pk_mul_f32 v[74:75], v[56:57], v[58:59] op_sel:[0,0] op_sel_hi:[1,0]
    v_pk_fma_f32 v[60:61], v[70:71], v[52:53], v[60:61] op_sel:[1,1,0] op_sel_hi:[0,1,1] neg_lo:[1,0,0]
    v_pk_fma_f32 v[62:63], v[54:55], v[52:53], v[62:63] op_sel:[1,1,0] op_sel_hi:[0,1,1] neg_lo:[1,0,0]
    v_pk_fma_f32 v[72:73], v[70:71], v[58:59], v[72:73] op_sel:[1,1,0] op_sel_hi:[0,1,1] neg_lo:[1,0,0]
    v_pk_fma_f32 v[74:75], v[56:57], v[58:59], v[74:75] op_sel:[1,1,0] op_sel_hi:[0,1,1] neg_lo:[1,0,0]
    v_cvt_pk_bf16_f32 v48, v54, -v55
    v_cvt_pk_bf16_f32 v49, v56, -v57
    ds_write_addtid_b32 v48 offset:49680
    ds_write_addtid_b32 v49 offset:50496
    v_pk_mul_f32 v[76:77], v[60:61], v[52:53] op_sel:[0,0] op_sel_hi:[1,0]
    v_pk_mul_f32 v[78:79], v[62:63], v[52:53] op_sel:[0,0] op_sel_hi:[1,0]
    v_pk_mul_f32 v[80:81], v[72:73], v[58:59] op_sel:[0,0] op_sel_hi:[1,0]
    v_pk_mul_f32 v[82:83], v[74:75], v[58:59] op_sel:[0,0] op_sel_hi:[1,0]
    v_pk_fma_f32 v[76:77], v[60:61], v[52:53], v[76:77] op_sel:[1,1,0] op_sel_hi:[0,1,1] neg_lo:[1,0,0]
    v_pk_fma_f32 v[78:79], v[62:63], v[52:53], v[78:79] op_sel:[1,1,0] op_sel_hi:[0,1,1] neg_lo:[1,0,0]
    v_pk_fma_f32 v[80:81], v[72:73], v[58:59], v[80:81] op_sel:[1,1,0] op_sel_hi:[0,1,1] neg_lo:[1,0,0]
    v_pk_fma_f32 v[82:83], v[74:75], v[58:59], v[82:83] op_sel:[1,1,0] op_sel_hi:[0,1,1] neg_lo:[1,0,0]
    v_cvt_pk_bf16_f32 v44, v60, -v61
    v_cvt_pk_bf16_f32 v45, v62, -v63
    v_cvt_pk_bf16_f32 v46, v72, -v73
    v_cvt_pk_bf16_f32 v47, v74, -v75
    ds_write_addtid_b32 v44 offset:49952
    ds_write_addtid_b32 v45 offset:50224
    ds_write_addtid_b32 v46 offset:55392
    ds_write_addtid_b32 v47 offset:57024
    v_pk_mul_f32 v[84:85], v[76:77], v[52:53] op_sel:[0,0] op_sel_hi:[1,0]
    v_pk_mul_f32 v[88:89], v[78:79], v[52:53] op_sel:[0,0] op_sel_hi:[1,0]
    v_pk_mul_f32 v[90:91], v[80:81], v[58:59] op_sel:[0,0] op_sel_hi:[1,0]
    v_pk_mul_f32 v[92:93], v[82:83], v[58:59] op_sel:[0,0] op_sel_hi:[1,0]
    v_pk_fma_f32 v[84:85], v[76:77], v[52:53], v[84:85] op_sel:[1,1,0] op_sel_hi:[0,1,1] neg_lo:[1,0,0]
    v_pk_fma_f32 v[88:89], v[78:79], v[52:53], v[88:89] op_sel:[1,1,0] op_sel_hi:[0,1,1] neg_lo:[1,0,0]
    v_pk_fma_f32 v[90:91], v[80:81], v[58:59], v[90:91] op_sel:[1,1,0] op_sel_hi:[0,1,1] neg_lo:[1,0,0]
    v_pk_fma_f32 v[92:93], v[82:83], v[58:59], v[92:93] op_sel:[1,1,0] op_sel_hi:[0,1,1] neg_lo:[1,0,0]
    v_cvt_pk_bf16_f32 v48, v76, -v77
    v_cvt_pk_bf16_f32 v49, v78, -v79
    v_cvt_pk_bf16_f32 v50, v80, -v81
    v_cvt_pk_bf16_f32 v51, v82, -v83
    ds_write_addtid_b32 v48 offset:51584
    ds_write_addtid_b32 v49 offset:51856
    ds_write_addtid_b32 v50 offset:54304
    ds_write_addtid_b32 v51 offset:55936
    v_pk_mul_f32 v[94:95], v[60:61], v[68:69] op_sel:[0,0] op_sel_hi:[1,0]
    v_pk_mul_f32 v[176:177], v[76:77], v[68:69] op_sel:[0,0] op_sel_hi:[1,0]
    v_pk_mul_f32 v[178:179], v[76:77], v[58:59] op_sel:[0,0] op_sel_hi:[1,0]
    v_pk_mul_f32 v[180:181], v[84:85], v[68:69] op_sel:[0,0] op_sel_hi:[1,0]
    v_pk_fma_f32 v[94:95], v[60:61], v[68:69], v[94:95] op_sel:[1,1,0] op_sel_hi:[0,1,1] neg_lo:[1,0,0]
    v_pk_fma_f32 v[176:177], v[76:77], v[68:69], v[176:177] op_sel:[1,1,0] op_sel_hi:[0,1,1] neg_lo:[1,0,0]
    v_pk_fma_f32 v[178:179], v[76:77], v[58:59], v[178:179] op_sel:[1,1,0] op_sel_hi:[0,1,1] neg_lo:[1,0,0]
    v_pk_fma_f32 v[180:181], v[84:85], v[68:69], v[180:181] op_sel:[1,1,0] op_sel_hi:[0,1,1] neg_lo:[1,0,0]
    v_cvt_pk_bf16_f32 v44, v84, -v85
    v_cvt_pk_bf16_f32 v45, v88, -v89
    v_cvt_pk_bf16_f32 v46, v90, -v91
    v_cvt_pk_bf16_f32 v47, v92, -v93
    s_waitcnt lgkmcnt(6)
    s_nop 0
    ds_write_addtid_b32 v44 offset:52128
    ds_write_addtid_b32 v45 offset:52400
    ds_write_addtid_b32 v46 offset:56480
    ds_write_addtid_b32 v47 offset:57568
    v_pk_mul_f32 v[182:183], v[56:57], v[66:67] op_sel:[0,0] op_sel_hi:[1,0]
    v_pk_mul_f32 v[184:185], v[72:73], v[66:67] op_sel:[0,0] op_sel_hi:[1,0]
    v_pk_mul_f32 v[186:187], v[74:75], v[66:67] op_sel:[0,0] op_sel_hi:[1,0]
    v_pk_mul_f32 v[188:189], v[80:81], v[66:67] op_sel:[0,0] op_sel_hi:[1,0]
    v_pk_fma_f32 v[182:183], v[56:57], v[66:67], v[182:183] op_sel:[1,1,0] op_sel_hi:[0,1,1] neg_lo:[1,0,0]
    v_pk_fma_f32 v[184:185], v[72:73], v[66:67], v[184:185] op_sel:[1,1,0] op_sel_hi:[0,1,1] neg_lo:[1,0,0]
    v_pk_fma_f32 v[186:187], v[74:75], v[66:67], v[186:187] op_sel:[1,1,0] op_sel_hi:[0,1,1] neg_lo:[1,0,0]
    v_pk_fma_f32 v[188:189], v[80:81], v[66:67], v[188:189] op_sel:[1,1,0] op_sel_hi:[0,1,1] neg_lo:[1,0,0]
    v_cvt_pk_bf16_f32 v48, v94, -v95
    v_cvt_pk_bf16_f32 v49, v176, -v177
    v_cvt_pk_bf16_f32 v50, v178, -v179
    v_cvt_pk_bf16_f32 v51, v180, -v181
    ds_write_addtid_b32 v48 offset:51040
    ds_write_addtid_b32 v49 offset:51312
    ds_write_addtid_b32 v49 offset:52944
    ds_write_addtid_b32 v50 offset:55664
    ds_write_addtid_b32 v51 offset:53216
    v_pk_mul_f32 v[190:191], v[82:83], v[66:67] op_sel:[0,0] op_sel_hi:[1,0]
    v_pk_mul_f32 v[54:55], v[90:91], v[66:67] op_sel:[0,0] op_sel_hi:[1,0]
    v_pk_mul_f32 v[62:63], v[92:93], v[66:67] op_sel:[0,0] op_sel_hi:[1,0]
    v_pk_mul_f32 v[78:79], v[176:177], v[58:59] op_sel:[0,0] op_sel_hi:[1,0]
    v_pk_mul_f32 v[84:85], v[180:181], v[86:87] op_sel:[0,0] op_sel_hi:[1,0]
    v_pk_fma_f32 v[190:191], v[82:83], v[66:67], v[190:191] op_sel:[1,1,0] op_sel_hi:[0,1,1] neg_lo:[1,0,0]
    v_pk_fma_f32 v[54:55], v[90:91], v[66:67], v[54:55] op_sel:[1,1,0] op_sel_hi:[0,1,1] neg_lo:[1,0,0]
    v_pk_fma_f32 v[62:63], v[92:93], v[66:67], v[62:63] op_sel:[1,1,0] op_sel_hi:[0,1,1] neg_lo:[1,0,0]
    v_pk_fma_f32 v[78:79], v[176:177], v[58:59], v[78:79] op_sel:[1,1,0] op_sel_hi:[0,1,1] neg_lo:[1,0,0]
    v_pk_fma_f32 v[84:85], v[180:181], v[86:87], v[84:85] op_sel:[1,1,0] op_sel_hi:[0,1,1] neg_lo:[1,0,0]
    v_cvt_pk_bf16_f32 v44, v182, -v183
    v_cvt_pk_bf16_f32 v45, v184, -v185
    v_cvt_pk_bf16_f32 v46, v186, -v187
    v_cvt_pk_bf16_f32 v47, v188, -v189
    s_waitcnt lgkmcnt(6)
    s_nop 0
    ds_write_addtid_b32 v44 offset:53488
    ds_write_addtid_b32 v45 offset:54848
    ds_write_addtid_b32 v46 offset:52672
    ds_write_addtid_b32 v47 offset:54576
    v_cvt_pk_bf16_f32 v48, v190, -v191
    v_cvt_pk_bf16_f32 v49, v54, -v55
    v_cvt_pk_bf16_f32 v50, v62, -v63
    v_cvt_pk_bf16_f32 v51, v78, -v79
    ds_write_addtid_b32 v48 offset:56208
    ds_write_addtid_b32 v49 offset:56752
    ds_write_addtid_b32 v50 offset:57840
    ds_write_addtid_b32 v51 offset:57296
    v_cvt_pk_bf16_f32 v44, v84, -v85
    s_waitcnt lgkmcnt(6)
    ds_write_addtid_b32 v44 offset:55120
    ds_write_b32 v2, v2
    s_setprio 0
    v_and_b32 v37, 31, v0
    v_lshrrev_b32 v38, 5, v0
    v_mul_u32_u24 v39, 272, v37
    v_lshl_add_u32 v39, v38, 4, v39
    s_mov_b32 s76, 49408
    s_cmp_eq_u32 s97, 1
    s_cselect_b32 s76, 66816, s76
    v_add_u32 v35, s76, v39
    s_mov_b32 s76, 58112
    s_cmp_eq_u32 s97, 1
    s_cselect_b32 s76, 114688, s76
    v_add_u32 v34, s76, v39
    v_and_b32 v40, 16, v0
    v_cmp_eq_u32 vcc, 0, v40
    s_mov_b32 s76, 123392
    s_cmp_eq_u32 s97, 1
    s_cselect_b32 s76, 132096, s76
    s_mov_b32 s77, 123392
    s_cmp_eq_u32 s97, 1
    s_cselect_b32 s77, 132096, s77
    v_add_u32 v40, s76, v39
    v_add_u32 v41, s77, v39
    v_cndmask_b32_e64 v12, v41, v40, vcc
    s_mov_b32 s76, 141568
    s_cmp_eq_u32 s97, 1
    s_cselect_b32 s76, 151808, s76
    s_mov_b32 s77, 142336
    s_cmp_eq_u32 s97, 1
    s_cselect_b32 s77, 152576, s77
    v_add_u32 v40, s76, v39
    v_add_u32 v41, s77, v39
    v_cndmask_b32_e64 v13, v41, v40, vcc
    s_cmp_eq_u32 s98, 0
    s_cbranch_scc0 L_sel1
    v_mov_b32 v208, 0x5040706
    v_mov_b32 v209, 0x5040706
    v_mov_b32 v210, 0x5040706
    v_mov_b32 v211, 0x5040504
    v_mov_b32 v212, 0x1000100
    v_mov_b32 v213, 0x7060706
    v_mov_b32 v214, 0x5040504
    v_mov_b32 v215, 0x5040504
    v_mov_b32 v216, 0x5040504
    v_mov_b32 v217, 0x7060706
    v_mov_b32 v218, 0x5040706
    s_mov_b32 exec_lo, 0x0
    s_mov_b32 exec_hi, 0xffffffff
    v_mov_b32 v209, 0x7060706
    v_mov_b32 v214, 0x5040706
    s_mov_b32 exec_lo, 0xffffffff
    s_mov_b32 exec_hi, 0x0
    v_mov_b32 v211, 0x5040706
    v_mov_b32 v212, 0x7060706
    s_mov_b32 exec_lo, 0x55555555
    s_mov_b32 exec_hi, 0x0
    s_nop 0
    v_mov_b32 v213, 0x5040706
    s_mov_b32 exec_lo, 0xaaaaaaaa
    s_mov_b32 exec_hi, 0xaaaaaaaa
    v_mov_b32 v218, 0x7060706
    s_mov_b64 exec, -1
    s_branch L_selx
L_sel1:
    v_mov_b32 v208, 0x1000302
    v_mov_b32 v209, 0x1000302
    v_mov_b32 v210, 0x1000100
    v_mov_b32 v211, 0x1000302
    v_mov_b32 v212, 0x7060706
    v_mov_b32 v213, 0x5040504
    v_mov_b32 v214, 0x5040504
    v_mov_b32 v215, 0x5040504
    v_mov_b32 v216, 0x5040504
    v_mov_b32 v217, 0x5040706
    v_mov_b32 v218, 0x5040504
    s_mov_b32 exec_lo, 0x0
    s_mov_b32 exec_hi, 0xffffffff
    v_mov_b32 v208, 0x3020302
    v_mov_b32 v209, 0x1000706
    v_mov_b32 v213, 0x5040706
    s_mov_b32 exec_lo, 0xffffffff
    s_mov_b32 exec_hi, 0x0
    v_mov_b32 v210, 0x1000302
    s_mov_b32 exec_lo, 0x0
    s_mov_b32 exec_hi, 0xfffffffe
    v_mov_b32 v211, 0x1000504
    s_mov_b32 exec_lo, 0x55555555
    s_mov_b32 exec_hi, 0x0
    v_mov_b32 v212, 0x5040706
    s_mov_b32 exec_lo, 0x0
    s_mov_b32 exec_hi, 0x1
    s_nop 0
    v_mov_b32 v215, 0x3020504
    s_mov_b32 exec_lo, 0xaaaaaaaa
    s_mov_b32 exec_hi, 0xaaaaaaaa
    v_mov_b32 v217, 0x7060706
    s_mov_b64 exec, -1
L_selx:
    s_setprio 3
    s_mov_b32 s77, 0
L_p0:

    ds_read_b128 v[56:59], v15
    s_add_u32 s77, s77, 1
    s_waitcnt lgkmcnt(0)
    v_and_b32 v56, v56, v57
    v_and_b32 v58, v58, v59
    v_and_b32 v56, v56, v58
    v_cmp_eq_u32_e64 vcc, 0, v56
    s_cmp_ge_u32 s77, 1000000
    s_cbranch_scc1 L_p0_x
    s_cbranch_vccnz L_p0
L_p0_x:
    ds_read_b128 v[96:99], v35 offset:0
    ds_read_b128 v[100:103], v12 offset:0
    ds_read_b128 v[104:107], v35 offset:32
    ds_read_b128 v[108:111], v12 offset:32
    ds_read_b128 v[112:115], v35 offset:64
    ds_read_b128 v[116:119], v12 offset:64
    ds_read_b128 v[120:123], v35 offset:96
    ds_read_b128 v[124:127], v12 offset:96
    ds_read_b128 v[128:131], v35 offset:128
    ds_read_b128 v[132:135], v12 offset:128
    s_waitcnt lgkmcnt(8)
    s_nop 0
    v_mfma_f32_32x32x16_bf16 v[160:175], v[96:99], v[100:103], 0
    ds_read_b128 v[136:139], v35 offset:160
    ds_read_b128 v[140:143], v12 offset:160
    s_mov_b32 s56, s42
    s_mov_b32 s57, s43
    s_waitcnt lgkmcnt(8)
    s_nop 0
    v_mfma_f32_32x32x16_bf16 v[160:175], v[104:107], v[108:111], v[160:175]
    ds_read_b128 v[96:99], v35 offset:192
    ds_read_b128 v[100:103], v12 offset:192
    s_mov_b32 s58, 16777216
    s_mov_b32 s59, 0x20000
    s_waitcnt lgkmcnt(8)
    s_nop 0
    v_mfma_f32_32x32x16_bf16 v[160:175], v[112:115], v[116:119], v[160:175]
    ds_read_b128 v[104:107], v35 offset:224
    ds_read_b128 v[108:111], v12 offset:224
    s_and_b32 s76, s66, 1
    s_lshl_b32 s76, s76, 13
    s_waitcnt lgkmcnt(8)
    s_nop 0
    v_mfma_f32_32x32x16_bf16 v[160:175], v[120:123], v[124:127], v[160:175]
    ds_read_b128 v[112:115], v34 offset:0
    ds_read_b128 v[116:119], v13 offset:0
    s_lshl_b32 s77, s96, 11
    s_add_u32 s76, s76, s77
    s_waitcnt lgkmcnt(8)
    s_nop 0
    v_mfma_f32_32x32x16_bf16 v[160:175], v[128:131], v[132:135], v[160:175]
    ds_read_b128 v[120:123], v34 offset:32
    ds_read_b128 v[124:127], v13 offset:32
    s_add_u32 s76, s76, 0
    v_lshrrev_b32_e64 v37, 4, v0
    s_waitcnt lgkmcnt(8)
    v_mfma_f32_32x32x16_bf16 v[160:175], v[136:139], v[140:143], v[160:175]
    ds_read_b128 v[128:131], v34 offset:64
    ds_read_b128 v[132:135], v13 offset:64
    v_bfe_u32 v38, v0, 1, 3
    v_xor_b32 v38, v37, v38
    s_waitcnt lgkmcnt(8)
    v_mfma_f32_32x32x16_bf16 v[160:175], v[96:99], v[100:103], v[160:175]
    ds_read_b128 v[136:139], v34 offset:96
    ds_read_b128 v[140:143], v13 offset:96
    v_lshlrev_b32 v38, 4, v38
    v_and_b32_e64 v39, 15, v0
    s_waitcnt lgkmcnt(8)
    v_mfma_f32_32x32x16_bf16 v[160:175], v[104:107], v[108:111], v[160:175]
    ds_read_b128 v[96:99], v34 offset:128
    ds_read_b128 v[100:103], v13 offset:128
    v_lshl_add_u32 v38, v39, 7, v38
    v_add_u32 v30, s76, v38
    s_waitcnt lgkmcnt(8)
    v_mfma_f32_32x32x16_bf16 v[160:175], v[112:115], v[116:119], v[160:175]
    ds_read_b128 v[104:107], v34 offset:160
    ds_read_b128 v[108:111], v13 offset:160
    v_xor_b32 v32, 64, v30
    v_lshlrev_b32_e64 v37, 4, v37
    s_waitcnt lgkmcnt(8)
    v_mfma_f32_32x32x16_bf16 v[160:175], v[120:123], v[124:127], v[160:175]
    ds_read_b128 v[112:115], v34 offset:192
    ds_read_b128 v[116:119], v13 offset:192
    v_add_u32 v31, 161280, v37
    s_mov_b32 s75, 0x7fff7fff
    s_waitcnt lgkmcnt(8)
    s_nop 0
    v_mfma_f32_32x32x16_bf16 v[160:175], v[128:131], v[132:135], v[160:175]
    ds_read_b128 v[120:123], v34 offset:224
    ds_read_b128 v[124:127], v13 offset:224
    s_mov_b32 s22, 0x20002000
    s_mov_b32 s23, 0x5fff5fff
    s_waitcnt lgkmcnt(8)
    v_mfma_f32_32x32x16_bf16 v[160:175], v[136:139], v[140:143], v[160:175]
    s_lshl2_add_u32 s78, s96, 163040
    v_mov_b32 v2, s78
    ds_write_b32 v2, v2
    s_waitcnt lgkmcnt(7)
    v_mfma_f32_32x32x16_bf16 v[160:175], v[96:99], v[100:103], v[160:175]
    s_waitcnt lgkmcnt(5)
    v_mfma_f32_32x32x16_bf16 v[160:175], v[104:107], v[108:111], v[160:175]
    s_waitcnt lgkmcnt(3)
    v_mfma_f32_32x32x16_bf16 v[160:175], v[112:115], v[116:119], v[160:175]
    s_waitcnt lgkmcnt(1)
    v_mfma_f32_32x32x16_bf16 v[160:175], v[120:123], v[124:127], v[160:175]
    s_cmp_ge_u32 s96, 2
    s_cbranch_scc1 L_nowait
    s_waitcnt vmcnt(0)
L_nowait:
    s_setprio 0
    s_barrier
    s_add_u32 s76, s69, 0
    s_and_b32 s76, s76, 7
    s_lshl_b32 s76, s76, 7
    v_add_u32_e64 v252, s76, v31
    ds_read_b128 v[232:235], v252
    ds_read_b128 v[236:239], v252 offset:64
    ds_read_b128 v[240:243], v30 offset:0
    ds_read_b128 v[244:247], v32 offset:0
    s_lshl_b32 s76, s97, 4
    s_lshr_b32 s7, s7, s76
    s_lshl_b32 s7, s7, 16
    v_cmp_eq_u32 vcc, 0, v0
    v_mov_b32 v38, s7
    s_nop 0
    v_cndmask_b32 v38, 0, v38, vcc
    s_nop 7
    v_add_f32_e64 v160, v160, v38
    v_cvt_pk_bf16_f32 v147, v166, v167
    v_cvt_pk_bf16_f32 v148, v168, v169
    v_cvt_pk_bf16_f32 v149, v170, v171
    v_cvt_pk_bf16_f32 v150, v172, v173
    v_cvt_pk_bf16_f32 v151, v174, v175
    v_cvt_pk_bf16_f32 v146, v164, v165
    v_cvt_pk_bf16_f32 v145, v162, v163
    v_cvt_pk_bf16_f32 v144, v160, v161
    v_mov_b32_dpp v152, v147 wave_shr:1 row_mask:0xf bank_mask:0xf bound_ctrl:0
    v_perm_b32 v164, v149, v148, v212
    v_perm_b32 v165, v149, v148, v213
    v_perm_b32 v166, v149, v148, v214
    v_perm_b32 v167, v149, v148, v215
    v_perm_b32 v168, v150, v146, v212
    v_perm_b32 v169, v150, v146, v213
    v_perm_b32 v170, v150, v146, v214
    v_perm_b32 v171, v150, v146, v216
    v_perm_b32 v172, v151, v151, v217
    v_perm_b32 v173, v151, v151, v218
    v_perm_b32 v174, v151, v151, v216
    v_perm_b32 v175, v151, v151, v216
    v_perm_b32 v160, v147, v146, v208
    v_perm_b32 v161, v146, v145, v209
    v_perm_b32 v162, v145, v144, v210
    v_perm_b32 v163, v144, v152, v211
    s_waitcnt lgkmcnt(0)
    v_mfma_f32_16x16x32_bf16 v[200:203], v[232:235], v[240:243], 0
    v_mfma_f32_16x16x32_bf16 v[200:203], v[236:239], v[244:247], v[200:203]
    s_barrier
    s_add_u32 s76, s69, 1
    s_and_b32 s76, s76, 7
    s_lshl_b32 s76, s76, 7
    v_add_u32 v252, s76, v31
    ds_read_b128 v[232:235], v252
    ds_read_b128 v[236:239], v252 offset:64
    ds_read_b128 v[240:243], v30 offset:16384
    ds_read_b128 v[244:247], v32 offset:16384
    s_cmp_ge_u32 s66, 8
    s_cbranch_scc1 L_not3
    s_and_b32 s76, s65, 3
    s_lshl3_add_u32 s76, s76, s66
    s_lshl2_add_u32 s76, s76, s96
    s_mul_i32 s76, s76, 43
    s_lshr_b32 s76, s76, 2
    v_min_u32 v28, 10, v0
    v_add_u32 v28, s76, v28
    v_lshlrev_b32 v28, 10, v28
    global_load_dword v254, v28, s[32:33] offset:384
L_not3:
    s_waitcnt lgkmcnt(0)
    v_mfma_f32_16x16x32_bf16 v[200:203], v[232:235], v[240:243], v[200:203]
    v_mfma_f32_16x16x32_bf16 v[200:203], v[236:239], v[244:247], v[200:203]
    s_barrier
    s_add_u32 s76, s69, 2
    s_and_b32 s76, s76, 7
    s_lshl_b32 s76, s76, 7
    v_add_u32 v252, s76, v31
    ds_read_b128 v[232:235], v252
    ds_read_b128 v[236:239], v252 offset:64
    ds_read_b128 v[240:243], v30 offset:32768
    ds_read_b128 v[244:247], v32 offset:32768
    v_and_b32 v37, 15, v0
    v_and_b32 v38, 48, v0
    v_lshrrev_b32_e64 v39, 1, v37
    v_lshl_add_u32 v39, v39, 6, v38
    v_and_b32 v40, 1, v0
    v_xor_b32 v40, 1, v40
    v_mul_u32_u24 v41, 5152, v40
    v_add_u32_e64 v39, v39, v41
    s_mul_i32 s76, s97, 10240
    s_lshl_b32 s77, s98, 8
    s_sub_u32 s76, s76, s77
    s_add_u32 s76, s76, 141120
    v_add_u32_e64 v4, s76, v39
    v_mul_u32_u24 v41, 4476, v40
    v_add_u32 v41, v41, v38
    v_lshlrev_b32 v39, 2, v37
    v_sub_u32_e64 v41, v41, v39
    s_mul_i32 s76, s97, 8704
    s_sub_u32 s76, s76, s77
    s_add_u32 s76, s76, 123708
    v_add_u32 v5, s76, v41
    s_mul_i32 s76, s97, 10240
    s_lshl_b32 s77, s98, 11
    s_add_u32 s76, s76, s77
    s_add_u32 s76, s76, 141312
    v_add_u32 v6, s76, v3
    v_and_b32_e64 v7, 48, v3

    s_waitcnt lgkmcnt(0)
    v_mfma_f32_16x16x32_bf16 v[200:203], v[232:235], v[240:243], v[200:203]
    v_mfma_f32_16x16x32_bf16 v[200:203], v[236:239], v[244:247], v[200:203]
    s_barrier
    s_add_u32 s76, s69, 3
    s_and_b32 s76, s76, 7
    s_lshl_b32 s76, s76, 7
    v_add_u32_e64 v252, s76, v31
    ds_read_b128 v[232:235], v252
    ds_read_b128 v[236:239], v252 offset:64
    ds_read_b128 v[240:243], v30 offset:49152
    ds_read_b128 v[244:247], v32 offset:49152
    v_mov_b32 v37, 162560
    ds_read_b32 v39, v37
    v_and_b32 v37, 7, v0
    s_waitcnt lgkmcnt(0)
    v_lshlrev_b32 v38, 1, v37
    v_lshrrev_b32 v38, v38, v39
    v_bfe_u32 v40, v38, 1, 1
    v_and_b32_e64 v38, 1, v38
    v_lshl_or_b32 v38, v40, 16, v38
    v_lshlrev_b32 v204, 14, v38
    v_lshlrev_b32 v38, 1, v0
    v_lshrrev_b32_e64 v38, v38, v39
    v_bfe_u32 v40, v38, 1, 1
    v_and_b32_e64 v38, 1, v38
    v_lshl_or_b32 v38, v40, 16, v38
    v_lshlrev_b32 v196, 14, v38
    v_and_b32 v37, 3, v0
    s_mul_i32 s76, s98, 12
    v_add_u32 v37, s76, v37
    v_lshlrev_b32 v38, 1, v37
    v_lshrrev_b32 v38, v38, v39
    v_bfe_u32 v40, v38, 1, 1
    v_and_b32_e64 v38, 1, v38
    v_lshl_or_b32 v38, v40, 16, v38
    v_lshlrev_b32_e64 v197, 14, v38
    v_mfma_f32_16x16x32_bf16 v[200:203], v[232:235], v[240:243], v[200:203]
    v_mfma_f32_16x16x32_bf16 v[200:203], v[236:239], v[244:247], v[200:203]
    s_barrier
    s_add_u32 s76, s69, 4
    s_and_b32 s76, s76, 7
    s_lshl_b32 s76, s76, 7
    v_add_u32_e64 v252, s76, v31
    ds_read_b128 v[232:235], v252
    ds_read_b128 v[236:239], v252 offset:64
    ds_read_b128 v[240:243], v30 offset:0
    ds_read_b128 v[244:247], v32 offset:0
    s_waitcnt lgkmcnt(0)
    v_mfma_f32_16x16x32_bf16 v[200:203], v[232:235], v[240:243], v[200:203]
    v_mfma_f32_16x16x32_bf16 v[200:203], v[236:239], v[244:247], v[200:203]
    s_barrier
    s_add_u32 s76, s69, 5
    s_and_b32 s76, s76, 7
    s_lshl_b32 s76, s76, 7
    v_add_u32 v252, s76, v31
    ds_read_b128 v[232:235], v252
    ds_read_b128 v[236:239], v252 offset:64
    ds_read_b128 v[240:243], v30 offset:16384
    ds_read_b128 v[244:247], v32 offset:16384
    s_lshl_b32 s79, s99, 12
    s_lshl_b32 s76, s98, 11
    s_add_u32 s79, s79, s76
    s_add_u32 s79, s79, 1048576
    s_lshl_b32 s76, s98, 6
    s_sub_u32 s78, s79, s76
    s_nop 0
    buffer_load_dwordx4 v[176:179], v3, s[56:59], s79 offen offset:0 sc1
    buffer_load_dwordx4 v[180:183], v3, s[56:59], s79 offen offset:1024 sc1
    buffer_load_dwordx4 v[184:187], v7, s[56:59], s78 offen sc1
    s_waitcnt lgkmcnt(0)
    v_mfma_f32_16x16x32_bf16 v[200:203], v[232:235], v[240:243], v[200:203]
    v_mfma_f32_16x16x32_bf16 v[200:203], v[236:239], v[244:247], v[200:203]
    s_barrier
    s_add_u32 s76, s69, 6
    s_and_b32 s76, s76, 7
    s_lshl_b32 s76, s76, 7
    v_add_u32 v252, s76, v31
    ds_read_b128 v[232:235], v252
    ds_read_b128 v[236:239], v252 offset:64
    ds_read_b128 v[240:243], v30 offset:32768
    ds_read_b128 v[244:247], v32 offset:32768
    s_waitcnt lgkmcnt(0)
    v_mfma_f32_16x16x32_bf16 v[200:203], v[232:235], v[240:243], v[200:203]
    v_mfma_f32_16x16x32_bf16 v[200:203], v[236:239], v[244:247], v[200:203]
    s_barrier
    s_add_u32 s76, s69, 7
    s_and_b32 s76, s76, 7
    s_lshl_b32 s76, s76, 7
    v_add_u32 v252, s76, v31
    ds_read_b128 v[232:235], v252
    ds_read_b128 v[236:239], v252 offset:64
    ds_read_b128 v[240:243], v30 offset:49152
    ds_read_b128 v[244:247], v32 offset:49152
    s_waitcnt vmcnt(0)
    v_xor_b32 v176, v196, v176
    v_xor_b32 v180, v196, v180
    v_xor_b32 v184, v197, v184
    v_add_u32 v42, s22, v177
    v_add_u32 v43, s22, v178
    v_and_b32 v40, v42, v43
    v_add_u32 v44, s22, v179
    v_add_u32_e64 v45, s22, v181
    v_bitop3_b32 v40, v40, v44, v45 bitop3:0x80
    v_add_u32 v42, s22, v182
    v_add_u32 v43, s22, v183
    v_bitop3_b32 v40, v40, v42, v43 bitop3:0x80
    v_add_u32 v44, s22, v185
    v_add_u32 v45, s22, v186
    v_bitop3_b32 v40, v40, v44, v45 bitop3:0x80
    v_add_u32 v42, s22, v187
    v_add_u32 v43, s22, v176
    v_bitop3_b32 v40, v40, v42, v43 bitop3:0x80
    v_add_u32 v44, s22, v180
    v_add_u32 v45, s22, v184
    v_bitop3_b32 v40, v40, v44, v45 bitop3:0x80
    v_and_b32 v40, 0x40004000, v40
    v_cmp_ne_u32 vcc, 0x40004000, v40
    s_cbranch_vccnz L_u_slow
L_u_ok:
    s_sub_u32 s76, 0, s98
    v_and_b32_e64 v187, s76, v187
    v_mov_b32_dpp v57, v179 wave_ror:1 row_mask:0xf bank_mask:0xf
    s_nop 0
    v_mov_b32_dpp v56, v187 wave_ror:1 row_mask:0xf bank_mask:0xf
    v_mov_b32_dpp v57, v183 wave_shr:1 row_mask:0xf bank_mask:0xf
    s_nop 0
    v_mov_b32_dpp v56, v179 wave_shr:1 row_mask:0xf bank_mask:0xf
    v_alignbit_b32 v49, v177, v176, 16
    v_alignbit_b32 v50, v178, v177, 16
    v_alignbit_b32 v51, v179, v178, 16
    v_alignbit_b32 v53, v181, v180, 16
    v_alignbit_b32 v54, v182, v181, 16
    v_alignbit_b32 v55, v183, v182, 16
    v_alignbit_b32 v48, v176, v56, 16
    v_alignbit_b32 v52, v180, v57, 16
    s_waitcnt lgkmcnt(0)
    v_mfma_f32_16x16x32_bf16 v[200:203], v[232:235], v[240:243], v[200:203]
    v_mfma_f32_16x16x32_bf16 v[200:203], v[236:239], v[244:247], v[200:203]
    s_waitcnt lgkmcnt(0)
    s_barrier
    s_setprio 3
    ds_write_b32 v11, v228 offset:16
    ds_write_b128 v9, v[164:167] offset:512
    ds_write_b128 v9, v[168:171]
    ds_write_b128 v8, v[172:175]
    ds_write_b128 v8, v[160:163] offset:3072
    ds_write_b128 v6, v[176:179] offset:0
    ds_write_b128 v6, v[180:183] offset:1024
    ds_write_b128 v6, v[48:51] offset:5152
    ds_write_b128 v6, v[52:55] offset:6176
    s_lshl_b32 s76, s96, 2
    s_add_u32 s76, s76, 162976
    v_mov_b32 v58, s76
    ds_write_b32 v58, v58
    v_xor_b32 v59, 4, v58
    s_mov_b32 s77, 0
L_pu:

    ds_read_b32 v56, v59
    s_add_u32 s77, s77, 1
    s_waitcnt lgkmcnt(0)
    v_cmp_eq_u32_e64 vcc, 0, v56
    s_cmp_ge_u32 s77, 1000000
    s_cbranch_scc1 L_pu_x
    s_cbranch_vccnz L_pu
L_pu_x:
    ds_read_b64 v[128:129], v5 offset:3776
    ds_read_b64 v[130:131], v5 offset:3784
    ds_read_b128 v[92:95], v4 offset:3776
    ds_read_b128 v[88:91], v4 offset:3264
    ds_read_b128 v[84:87], v4 offset:2752
    ds_read_b128 v[80:83], v4 offset:2240
    ds_read_b128 v[76:79], v4 offset:1728
    ds_read_b128 v[72:75], v4 offset:1216
    ds_read_b128 v[68:71], v4 offset:704
    ds_read_b128 v[64:67], v4 offset:192
    ds_read_b64 v[132:133], v5 offset:3264
    ds_read_b64 v[134:135], v5 offset:3272
    ds_read_b64 v[136:137], v5 offset:2752
    ds_read_b64 v[138:139], v5 offset:2760
    s_waitcnt lgkmcnt(11)
    v_mfma_f32_16x16x32_bf16 v[124:127], v[92:95], v[128:131], 0
    ds_read_b128 v[92:95], v4 offset:3712
    s_waitcnt lgkmcnt(11)
    v_mfma_f32_16x16x32_bf16 v[120:123], v[88:91], v[128:131], 0
    s_waitcnt lgkmcnt(10)
    v_mfma_f32_16x16x32_bf16 v[116:119], v[84:87], v[128:131], 0
    s_waitcnt lgkmcnt(9)
    v_mfma_f32_16x16x32_bf16 v[112:115], v[80:83], v[128:131], 0
    ds_read_b64 v[140:141], v5 offset:2240
    ds_read_b64 v[142:143], v5 offset:2248
    s_waitcnt lgkmcnt(10)
    s_nop 0
    v_mfma_f32_16x16x32_bf16 v[108:111], v[76:79], v[128:131], 0
    ds_read_b64 v[144:145], v5 offset:1728
    ds_read_b64 v[146:147], v5 offset:1736
    s_waitcnt lgkmcnt(11)
    s_nop 0
    v_mfma_f32_16x16x32_bf16 v[104:107], v[72:75], v[128:131], 0
    ds_read_b64 v[148:149], v5 offset:1216
    ds_read_b64 v[150:151], v5 offset:1224
    s_waitcnt lgkmcnt(12)
    s_nop 0
    v_mfma_f32_16x16x32_bf16 v[100:103], v[68:71], v[128:131], 0
    ds_read_b64 v[152:153], v5 offset:704
    ds_read_b64 v[154:155], v5 offset:712
    s_waitcnt lgkmcnt(13)
    s_nop 0
    v_mfma_f32_16x16x32_bf16 v[96:99], v[64:67], v[128:131], 0
    ds_read_b64 v[156:157], v5 offset:192
    ds_read_b64 v[158:159], v5 offset:200
    s_waitcnt lgkmcnt(13)
    v_mfma_f32_16x16x32_bf16 v[124:127], v[88:91], v[132:135], v[124:127]
    ds_read_b128 v[88:91], v4 offset:3200
    s_waitcnt lgkmcnt(6)
    ds_read_b64 v[128:129], v5 offset:3712
    ds_read_b64 v[130:131], v5 offset:3720
    v_mfma_f32_16x16x32_bf16 v[120:123], v[84:87], v[132:135], v[120:123]
    v_mfma_f32_16x16x32_bf16 v[116:119], v[80:83], v[132:135], v[116:119]
    v_mfma_f32_16x16x32_bf16 v[112:115], v[76:79], v[132:135], v[112:115]
    v_mfma_f32_16x16x32_bf16 v[108:111], v[72:75], v[132:135], v[108:111]
    v_mfma_f32_16x16x32_bf16 v[104:107], v[68:71], v[132:135], v[104:107]
    v_mfma_f32_16x16x32_bf16 v[100:103], v[64:67], v[132:135], v[100:103]
    v_mfma_f32_16x16x32_bf16 v[124:127], v[84:87], v[136:139], v[124:127]
    ds_read_b128 v[84:87], v4 offset:2688
    ds_read_b64 v[132:133], v5 offset:3200
    ds_read_b64 v[134:135], v5 offset:3208
    v_mfma_f32_16x16x32_bf16 v[120:123], v[80:83], v[136:139], v[120:123]
    v_mfma_f32_16x16x32_bf16 v[116:119], v[76:79], v[136:139], v[116:119]
    v_mfma_f32_16x16x32_bf16 v[112:115], v[72:75], v[136:139], v[112:115]
    v_mfma_f32_16x16x32_bf16 v[108:111], v[68:71], v[136:139], v[108:111]
    v_mfma_f32_16x16x32_bf16 v[104:107], v[64:67], v[136:139], v[104:107]
    v_mfma_f32_16x16x32_bf16 v[124:127], v[80:83], v[140:143], v[124:127]
    ds_read_b128 v[80:83], v4 offset:2176
    ds_read_b64 v[136:137], v5 offset:2688
    ds_read_b64 v[138:139], v5 offset:2696
    v_mfma_f32_16x16x32_bf16 v[120:123], v[76:79], v[140:143], v[120:123]
    v_mfma_f32_16x16x32_bf16 v[116:119], v[72:75], v[140:143], v[116:119]
    v_mfma_f32_16x16x32_bf16 v[112:115], v[68:71], v[140:143], v[112:115]
    v_mfma_f32_16x16x32_bf16 v[108:111], v[64:67], v[140:143], v[108:111]
    v_mfma_f32_16x16x32_bf16 v[124:127], v[76:79], v[144:147], v[124:127]
    ds_read_b128 v[76:79], v4 offset:1664
    s_waitcnt lgkmcnt(6)
    s_nop 0
    ds_read_b64 v[140:141], v5 offset:2176
    ds_read_b64 v[142:143], v5 offset:2184
    v_mfma_f32_16x16x32_bf16 v[120:123], v[72:75], v[144:147], v[120:123]
    v_mfma_f32_16x16x32_bf16 v[116:119], v[68:71], v[144:147], v[116:119]
    v_mfma_f32_16x16x32_bf16 v[112:115], v[64:67], v[144:147], v[112:115]
    v_mfma_f32_16x16x32_bf16 v[124:127], v[72:75], v[148:151], v[124:127]
    ds_read_b128 v[72:75], v4 offset:1152
    ds_read_b64 v[144:145], v5 offset:1664
    ds_read_b64 v[146:147], v5 offset:1672
    v_mfma_f32_16x16x32_bf16 v[120:123], v[68:71], v[148:151], v[120:123]
    v_mfma_f32_16x16x32_bf16 v[116:119], v[64:67], v[148:151], v[116:119]
    v_mfma_f32_16x16x32_bf16 v[124:127], v[68:71], v[152:155], v[124:127]
    ds_read_b128 v[68:71], v4 offset:640
    ds_read_b64 v[148:149], v5 offset:1152
    ds_read_b64 v[150:151], v5 offset:1160
    v_mfma_f32_16x16x32_bf16 v[120:123], v[64:67], v[152:155], v[120:123]
    v_mfma_f32_16x16x32_bf16 v[124:127], v[64:67], v[156:159], v[124:127]
    ds_read_b128 v[64:67], v4 offset:128
    s_waitcnt lgkmcnt(6)
    s_nop 0
    ds_read_b64 v[152:153], v5 offset:640
    ds_read_b64 v[154:155], v5 offset:648
    ds_read_b64 v[156:157], v5 offset:128
    ds_read_b64 v[158:159], v5 offset:136
    v_mfma_f32_16x16x32_bf16 v[124:127], v[92:95], v[128:131], v[124:127]
    ds_read_b128 v[92:95], v4 offset:3648
    v_mfma_f32_16x16x32_bf16 v[120:123], v[88:91], v[128:131], v[120:123]
    v_mfma_f32_16x16x32_bf16 v[116:119], v[84:87], v[128:131], v[116:119]
    v_mfma_f32_16x16x32_bf16 v[112:115], v[80:83], v[128:131], v[112:115]
    v_mfma_f32_16x16x32_bf16 v[108:111], v[76:79], v[128:131], v[108:111]
    v_mfma_f32_16x16x32_bf16 v[104:107], v[72:75], v[128:131], v[104:107]
    s_waitcnt lgkmcnt(8)
    v_mfma_f32_16x16x32_bf16 v[100:103], v[68:71], v[128:131], v[100:103]
    s_waitcnt lgkmcnt(5)
    v_mfma_f32_16x16x32_bf16 v[96:99], v[64:67], v[128:131], v[96:99]
    v_mfma_f32_16x16x32_bf16 v[124:127], v[88:91], v[132:135], v[124:127]
    ds_read_b128 v[88:91], v4 offset:3136
    ds_read_b64 v[128:129], v5 offset:3648
    ds_read_b64 v[130:131], v5 offset:3656
    v_mfma_f32_16x16x32_bf16 v[120:123], v[84:87], v[132:135], v[120:123]
    v_mfma_f32_16x16x32_bf16 v[116:119], v[80:83], v[132:135], v[116:119]
    v_mfma_f32_16x16x32_bf16 v[112:115], v[76:79], v[132:135], v[112:115]
    v_mfma_f32_16x16x32_bf16 v[108:111], v[72:75], v[132:135], v[108:111]
    v_mfma_f32_16x16x32_bf16 v[104:107], v[68:71], v[132:135], v[104:107]
    v_mfma_f32_16x16x32_bf16 v[100:103], v[64:67], v[132:135], v[100:103]
    v_mfma_f32_16x16x32_bf16 v[124:127], v[84:87], v[136:139], v[124:127]
    ds_read_b128 v[84:87], v4 offset:2624
    ds_read_b64 v[132:133], v5 offset:3136
    ds_read_b64 v[134:135], v5 offset:3144
    v_mfma_f32_16x16x32_bf16 v[120:123], v[80:83], v[136:139], v[120:123]
    v_mfma_f32_16x16x32_bf16 v[116:119], v[76:79], v[136:139], v[116:119]
    v_mfma_f32_16x16x32_bf16 v[112:115], v[72:75], v[136:139], v[112:115]
    v_mfma_f32_16x16x32_bf16 v[108:111], v[68:71], v[136:139], v[108:111]
    v_mfma_f32_16x16x32_bf16 v[104:107], v[64:67], v[136:139], v[104:107]
    v_mfma_f32_16x16x32_bf16 v[124:127], v[80:83], v[140:143], v[124:127]
    ds_read_b128 v[80:83], v4 offset:2112
    ds_read_b64 v[136:137], v5 offset:2624
    ds_read_b64 v[138:139], v5 offset:2632
    v_mfma_f32_16x16x32_bf16 v[120:123], v[76:79], v[140:143], v[120:123]
    v_mfma_f32_16x16x32_bf16 v[116:119], v[72:75], v[140:143], v[116:119]
    v_mfma_f32_16x16x32_bf16 v[112:115], v[68:71], v[140:143], v[112:115]
    v_mfma_f32_16x16x32_bf16 v[108:111], v[64:67], v[140:143], v[108:111]
    v_mfma_f32_16x16x32_bf16 v[124:127], v[76:79], v[144:147], v[124:127]
    ds_read_b128 v[76:79], v4 offset:1600
    s_waitcnt lgkmcnt(6)
    s_nop 0
    ds_read_b64 v[140:141], v5 offset:2112
    ds_read_b64 v[142:143], v5 offset:2120
    v_mfma_f32_16x16x32_bf16 v[120:123], v[72:75], v[144:147], v[120:123]
    v_mfma_f32_16x16x32_bf16 v[116:119], v[68:71], v[144:147], v[116:119]
    v_mfma_f32_16x16x32_bf16 v[112:115], v[64:67], v[144:147], v[112:115]
    v_mfma_f32_16x16x32_bf16 v[124:127], v[72:75], v[148:151], v[124:127]
    ds_read_b128 v[72:75], v4 offset:1088
    ds_read_b64 v[144:145], v5 offset:1600
    ds_read_b64 v[146:147], v5 offset:1608
    v_mfma_f32_16x16x32_bf16 v[120:123], v[68:71], v[148:151], v[120:123]
    v_mfma_f32_16x16x32_bf16 v[116:119], v[64:67], v[148:151], v[116:119]
    v_mfma_f32_16x16x32_bf16 v[124:127], v[68:71], v[152:155], v[124:127]
    ds_read_b128 v[68:71], v4 offset:576
    ds_read_b64 v[148:149], v5 offset:1088
    ds_read_b64 v[150:151], v5 offset:1096
    v_mfma_f32_16x16x32_bf16 v[120:123], v[64:67], v[152:155], v[120:123]
    v_mfma_f32_16x16x32_bf16 v[124:127], v[64:67], v[156:159], v[124:127]
    ds_read_b128 v[64:67], v4 offset:64
    s_waitcnt lgkmcnt(6)
    s_nop 0
    ds_read_b64 v[152:153], v5 offset:576
    ds_read_b64 v[154:155], v5 offset:584
    ds_read_b64 v[156:157], v5 offset:64
    ds_read_b64 v[158:159], v5 offset:72
    v_mfma_f32_16x16x32_bf16 v[124:127], v[92:95], v[128:131], v[124:127]
    ds_read_b128 v[92:95], v4 offset:3584
    v_mfma_f32_16x16x32_bf16 v[120:123], v[88:91], v[128:131], v[120:123]
    v_mfma_f32_16x16x32_bf16 v[116:119], v[84:87], v[128:131], v[116:119]
    v_mfma_f32_16x16x32_bf16 v[112:115], v[80:83], v[128:131], v[112:115]
    v_mfma_f32_16x16x32_bf16 v[108:111], v[76:79], v[128:131], v[108:111]
    v_mfma_f32_16x16x32_bf16 v[104:107], v[72:75], v[128:131], v[104:107]
    s_waitcnt lgkmcnt(8)
    v_mfma_f32_16x16x32_bf16 v[100:103], v[68:71], v[128:131], v[100:103]
    s_waitcnt lgkmcnt(5)
    v_mfma_f32_16x16x32_bf16 v[96:99], v[64:67], v[128:131], v[96:99]
    v_mfma_f32_16x16x32_bf16 v[124:127], v[88:91], v[132:135], v[124:127]
    ds_read_b128 v[88:91], v4 offset:3072
    ds_read_b64 v[128:129], v5 offset:3584
    ds_read_b64 v[130:131], v5 offset:3592
    v_mfma_f32_16x16x32_bf16 v[120:123], v[84:87], v[132:135], v[120:123]
    v_mfma_f32_16x16x32_bf16 v[116:119], v[80:83], v[132:135], v[116:119]
    v_mfma_f32_16x16x32_bf16 v[112:115], v[76:79], v[132:135], v[112:115]
    v_mfma_f32_16x16x32_bf16 v[108:111], v[72:75], v[132:135], v[108:111]
    v_mfma_f32_16x16x32_bf16 v[104:107], v[68:71], v[132:135], v[104:107]
    v_mfma_f32_16x16x32_bf16 v[100:103], v[64:67], v[132:135], v[100:103]
    v_mfma_f32_16x16x32_bf16 v[124:127], v[84:87], v[136:139], v[124:127]
    ds_read_b128 v[84:87], v4 offset:2560
    ds_read_b64 v[132:133], v5 offset:3072
    ds_read_b64 v[134:135], v5 offset:3080
    v_mfma_f32_16x16x32_bf16 v[120:123], v[80:83], v[136:139], v[120:123]
    v_mfma_f32_16x16x32_bf16 v[116:119], v[76:79], v[136:139], v[116:119]
    v_mfma_f32_16x16x32_bf16 v[112:115], v[72:75], v[136:139], v[112:115]
    v_mfma_f32_16x16x32_bf16 v[108:111], v[68:71], v[136:139], v[108:111]
    v_mfma_f32_16x16x32_bf16 v[104:107], v[64:67], v[136:139], v[104:107]
    v_mfma_f32_16x16x32_bf16 v[124:127], v[80:83], v[140:143], v[124:127]
    ds_read_b128 v[80:83], v4 offset:2048
    ds_read_b64 v[136:137], v5 offset:2560
    ds_read_b64 v[138:139], v5 offset:2568
    v_mfma_f32_16x16x32_bf16 v[120:123], v[76:79], v[140:143], v[120:123]
    v_mfma_f32_16x16x32_bf16 v[116:119], v[72:75], v[140:143], v[116:119]
    v_mfma_f32_16x16x32_bf16 v[112:115], v[68:71], v[140:143], v[112:115]
    v_mfma_f32_16x16x32_bf16 v[108:111], v[64:67], v[140:143], v[108:111]
    v_mfma_f32_16x16x32_bf16 v[124:127], v[76:79], v[144:147], v[124:127]
    ds_read_b128 v[76:79], v4 offset:1536
    s_waitcnt lgkmcnt(6)
    s_nop 0
    ds_read_b64 v[140:141], v5 offset:2048
    ds_read_b64 v[142:143], v5 offset:2056
    v_mfma_f32_16x16x32_bf16 v[120:123], v[72:75], v[144:147], v[120:123]
    v_mfma_f32_16x16x32_bf16 v[116:119], v[68:71], v[144:147], v[116:119]
    v_mfma_f32_16x16x32_bf16 v[112:115], v[64:67], v[144:147], v[112:115]
    v_mfma_f32_16x16x32_bf16 v[124:127], v[72:75], v[148:151], v[124:127]
    ds_read_b128 v[72:75], v4 offset:1024
    ds_read_b64 v[144:145], v5 offset:1536
    ds_read_b64 v[146:147], v5 offset:1544
    v_mfma_f32_16x16x32_bf16 v[120:123], v[68:71], v[148:151], v[120:123]
    v_mfma_f32_16x16x32_bf16 v[116:119], v[64:67], v[148:151], v[116:119]
    v_mfma_f32_16x16x32_bf16 v[124:127], v[68:71], v[152:155], v[124:127]
    ds_read_b128 v[68:71], v4 offset:512
    ds_read_b64 v[148:149], v5 offset:1024
    ds_read_b64 v[150:151], v5 offset:1032
    v_mfma_f32_16x16x32_bf16 v[120:123], v[64:67], v[152:155], v[120:123]
    v_mfma_f32_16x16x32_bf16 v[124:127], v[64:67], v[156:159], v[124:127]
    ds_read_b128 v[64:67], v4 offset:0
    s_waitcnt lgkmcnt(6)
    s_nop 0
    ds_read_b64 v[152:153], v5 offset:512
    ds_read_b64 v[154:155], v5 offset:520
    ds_read_b64 v[156:157], v5 offset:0
    ds_read_b64 v[158:159], v5 offset:8
    v_mfma_f32_16x16x32_bf16 v[124:127], v[92:95], v[128:131], v[124:127]
    v_mfma_f32_16x16x32_bf16 v[120:123], v[88:91], v[128:131], v[120:123]
    v_mfma_f32_16x16x32_bf16 v[116:119], v[84:87], v[128:131], v[116:119]
    v_mfma_f32_16x16x32_bf16 v[112:115], v[80:83], v[128:131], v[112:115]
    v_mfma_f32_16x16x32_bf16 v[108:111], v[76:79], v[128:131], v[108:111]
    v_mfma_f32_16x16x32_bf16 v[104:107], v[72:75], v[128:131], v[104:107]
    s_waitcnt lgkmcnt(7)
    v_mfma_f32_16x16x32_bf16 v[100:103], v[68:71], v[128:131], v[100:103]
    s_waitcnt lgkmcnt(4)
    v_mfma_f32_16x16x32_bf16 v[96:99], v[64:67], v[128:131], v[96:99]
    v_mfma_f32_16x16x32_bf16 v[124:127], v[88:91], v[132:135], v[124:127]
    s_lshl2_add_u32 s76, s96, 162944
    v_mov_b32 v50, s76
    v_mov_b32 v51, 1
    ds_write_b32 v50, v51
    v_mfma_f32_16x16x32_bf16 v[120:123], v[84:87], v[132:135], v[120:123]
    v_mfma_f32_16x16x32_bf16 v[116:119], v[80:83], v[132:135], v[116:119]
    v_mfma_f32_16x16x32_bf16 v[112:115], v[76:79], v[132:135], v[112:115]
    v_mfma_f32_16x16x32_bf16 v[108:111], v[72:75], v[132:135], v[108:111]
    v_mfma_f32_16x16x32_bf16 v[104:107], v[68:71], v[132:135], v[104:107]
    v_mfma_f32_16x16x32_bf16 v[100:103], v[64:67], v[132:135], v[100:103]
    v_mfma_f32_16x16x32_bf16 v[124:127], v[84:87], v[136:139], v[124:127]
    v_mfma_f32_16x16x32_bf16 v[120:123], v[80:83], v[136:139], v[120:123]
    v_mfma_f32_16x16x32_bf16 v[116:119], v[76:79], v[136:139], v[116:119]
    v_mfma_f32_16x16x32_bf16 v[112:115], v[72:75], v[136:139], v[112:115]
    v_mfma_f32_16x16x32_bf16 v[108:111], v[68:71], v[136:139], v[108:111]
    v_mfma_f32_16x16x32_bf16 v[104:107], v[64:67], v[136:139], v[104:107]
    v_mfma_f32_16x16x32_bf16 v[124:127], v[80:83], v[140:143], v[124:127]
    v_mfma_f32_16x16x32_bf16 v[120:123], v[76:79], v[140:143], v[120:123]
    v_mfma_f32_16x16x32_bf16 v[116:119], v[72:75], v[140:143], v[116:119]
    v_mfma_f32_16x16x32_bf16 v[112:115], v[68:71], v[140:143], v[112:115]
    v_mfma_f32_16x16x32_bf16 v[108:111], v[64:67], v[140:143], v[108:111]
    v_mfma_f32_16x16x32_bf16 v[124:127], v[76:79], v[144:147], v[124:127]
    v_mfma_f32_16x16x32_bf16 v[120:123], v[72:75], v[144:147], v[120:123]
    v_mfma_f32_16x16x32_bf16 v[116:119], v[68:71], v[144:147], v[116:119]
    v_mfma_f32_16x16x32_bf16 v[112:115], v[64:67], v[144:147], v[112:115]
    v_mfma_f32_16x16x32_bf16 v[124:127], v[72:75], v[148:151], v[124:127]
    v_mfma_f32_16x16x32_bf16 v[120:123], v[68:71], v[148:151], v[120:123]
    v_mfma_f32_16x16x32_bf16 v[116:119], v[64:67], v[148:151], v[116:119]
    s_waitcnt lgkmcnt(3)
    v_mfma_f32_16x16x32_bf16 v[124:127], v[68:71], v[152:155], v[124:127]
    v_mfma_f32_16x16x32_bf16 v[120:123], v[64:67], v[152:155], v[120:123]
    s_waitcnt lgkmcnt(1)
    v_mfma_f32_16x16x32_bf16 v[124:127], v[64:67], v[156:159], v[124:127]
    v_xor_b32 v52, 4, v50
    v_add_u32_e64 v55, 16, v52
    s_xor_b32 s76, s96, 1
    s_mul_i32 s76, s76, 5120
    s_add_u32 s76, s76, 140800
    v_add_u32 v54, s76, v3
    s_mov_b32 s77, 0
L_p1:

    ds_read_b32 v56, v52
    s_add_u32 s77, s77, 1
    s_waitcnt lgkmcnt(0)
    v_cmp_eq_u32_e64 vcc, 0, v56
    s_cmp_ge_u32 s77, 1000000
    s_cbranch_scc1 L_p1_x
    s_cbranch_vccnz L_p1
L_p1_x:
    s_cmp_eq_u32 s98, 0
    s_cbranch_scc1 L_cx0
    ds_write_b128 v14, v[96:99] offset:0
    ds_write_b128 v14, v[100:103] offset:1024
    ds_write_b128 v14, v[104:107] offset:2048
    ds_write_b128 v14, v[108:111] offset:3072
    ds_write_b32 v50, v51 offset:16
    v_mov_b32 v96, v112
    v_mov_b32 v97, v113
    v_mov_b32 v98, v114
    v_mov_b32 v99, v115
    v_mov_b32 v100, v116
    v_mov_b32 v101, v117
    v_mov_b32 v102, v118
    v_mov_b32 v103, v119
    v_mov_b32 v104, v120
    v_mov_b32 v105, v121
    v_mov_b32 v106, v122
    v_mov_b32 v107, v123
    v_mov_b32 v108, v124
    v_mov_b32 v109, v125
    v_mov_b32 v110, v126
    v_mov_b32_e64 v111, v127
    s_branch L_cx1
L_cx0:
    ds_write_b128 v14, v[112:115] offset:0
    ds_write_b128 v14, v[116:119] offset:1024
    ds_write_b128 v14, v[120:123] offset:2048
    ds_write_b128 v14, v[124:127] offset:3072
    ds_write_b32 v50, v51 offset:16
L_cx1:
    v_lshrrev_b32_e64 v60, 4, v0
    v_bfe_u32 v61, v0, 3, 1
    v_lshl_add_u32 v60, v61, 2, v60
    v_lshlrev_b32 v60, 16, v60
    v_and_b32 v61, 7, v0
    v_lshl_add_u32 v60, v61, 4, v60
    s_lshl_b32 s78, s98, 20
    s_lshr_b32 s76, s3, 5
    s_lshl_b32 s76, s76, 13
    s_add_u32 s78, s78, s76
    s_and_b32 s76, s99, 63
    s_lshl_b32 s76, s76, 7
    s_add_u32 s78, s78, s76
    s_add_u32 s78, s78, 12582912
    s_add_u32 s79, s78, 524288
    s_mov_b32 s77, 0
L_p2:

    ds_read_b32 v56, v55
    s_add_u32 s77, s77, 1
    s_waitcnt lgkmcnt(0)
    v_cmp_eq_u32_e64 vcc, 0, v56
    s_cmp_ge_u32 s77, 1000000
    s_cbranch_scc1 L_p2_x
    s_cbranch_vccnz L_p2
L_p2_x:
    ds_read_b128 v[64:67], v54 offset:0
    ds_read_b128 v[68:71], v54 offset:1024
    ds_read_b128 v[72:75], v54 offset:2048
    ds_read_b128 v[76:79], v54 offset:3072
    s_waitcnt lgkmcnt(3)
    v_add_f32 v96, v96, v64
    v_add_f32 v97, v97, v65
    v_add_f32 v98, v98, v66
    v_add_f32_e64 v99, v99, v67
    v_cvt_pk_bf16_f32 v144, v96, v97
    v_cvt_pk_bf16_f32 v146, v98, v99
    s_waitcnt lgkmcnt(2)
    v_add_f32 v100, v100, v68
    v_add_f32 v101, v101, v69
    v_add_f32 v102, v102, v70
    v_add_f32_e64 v103, v103, v71
    v_cvt_pk_bf16_f32 v145, v100, v101
    v_cvt_pk_bf16_f32 v147, v102, v103
    s_waitcnt lgkmcnt(1)
    v_add_f32 v104, v104, v72
    v_add_f32 v105, v105, v73
    v_add_f32 v106, v106, v74
    v_add_f32_e64 v107, v107, v75
    v_cvt_pk_bf16_f32 v148, v104, v105
    v_cvt_pk_bf16_f32 v150, v106, v107
    s_waitcnt lgkmcnt(0)
    v_add_f32 v108, v108, v76
    v_add_f32 v109, v109, v77
    v_add_f32 v110, v110, v78
    v_add_f32_e64 v111, v111, v79
    v_cvt_pk_bf16_f32 v149, v108, v109
    v_cvt_pk_bf16_f32 v151, v110, v111
    v_mov_b32 v152, v144
    v_mov_b32 v153, v146
    v_mov_b32 v154, v148
    v_mov_b32 v155, v150
    v_mov_b32_dpp v144, v145 row_ror:8 row_mask:0xf bank_mask:0xc
    v_mov_b32_dpp v146, v147 row_ror:8 row_mask:0xf bank_mask:0xc
    v_mov_b32_dpp v148, v149 row_ror:8 row_mask:0xf bank_mask:0xc
    v_mov_b32_dpp v150, v151 row_ror:8 row_mask:0xf bank_mask:0xc
    v_mov_b32_dpp v145, v152 row_ror:8 row_mask:0xf bank_mask:0x3
    v_mov_b32_dpp v147, v153 row_ror:8 row_mask:0xf bank_mask:0x3
    v_mov_b32_dpp v149, v154 row_ror:8 row_mask:0xf bank_mask:0x3
    v_mov_b32_dpp v151, v155 row_ror:8 row_mask:0xf bank_mask:0x3
    v_and_b32 v128, s75, v144
    v_and_b32 v129, s75, v145
    v_and_b32 v130, s75, v146
    v_and_b32 v131, s75, v147
    v_and_b32 v132, s75, v148
    v_and_b32 v133, s75, v149
    v_and_b32 v134, s75, v150
    v_and_b32 v135, s75, v151
    v_pk_max_u16 v128, v128, s22
    v_pk_max_u16 v129, v129, s22
    v_pk_max_u16 v130, v130, s22
    v_pk_max_u16 v131, v131, s22
    v_pk_max_u16 v132, v132, s22
    v_pk_max_u16 v133, v133, s22
    v_pk_max_u16 v134, v134, s22
    v_pk_max_u16 v135, v135, s22
    v_pk_min_u16 v128, v128, s23
    v_pk_min_u16 v129, v129, s23
    v_pk_min_u16 v130, v130, s23
    v_pk_min_u16 v131, v131, s23
    v_pk_min_u16 v132, v132, s23
    v_pk_min_u16 v133, v133, s23
    v_pk_min_u16 v134, v134, s23
    v_pk_min_u16 v135, v135, s23
    v_bfi_b32 v144, s75, v128, v144
    v_bfi_b32 v145, s75, v129, v145
    v_bfi_b32 v146, s75, v130, v146
    v_bfi_b32 v147, s75, v131, v147
    v_bfi_b32 v148, s75, v132, v148
    v_bfi_b32 v149, s75, v133, v149
    v_bfi_b32 v150, s75, v134, v150
    v_bfi_b32 v151, s75, v135, v151
    v_xor_b32 v144, v204, v144
    v_xor_b32 v148, v204, v148
    buffer_store_dwordx4 v[144:147], v60, s[56:59], s78 offen sc1
    buffer_store_dwordx4 v[148:151], v60, s[56:59], s79 offen sc1
    v_mul_f32 v200, 0xbfb8aa3b, v200
    v_exp_f32 v200, v200
    v_and_b32 v37, 15, v0
    v_add_f32 v200, 1.0, v200
    v_rcp_f32_e64 v200, v200
    s_lshl_b32 s76, s96, 6
    s_add_u32 s76, s76, 162688
    v_lshl_add_u32 v37, v37, 2, s76
    s_mov_b64 exec, 0xffff
    ds_write_b32 v37, v200
    s_mov_b64 exec, -1
    s_lshl_b32 s79, s67, 3
    s_add_u32 s79, s79, s68
    s_lshl_b32 s79, s79, 13
    s_lshl_b32 s76, s96, 11
    s_add_u32 s79, s79, s76
    s_add_u32 s79, s79, 12582912
    v_mov_b32 v52, 162944
    s_lshl_b32 s76, s96, 1
    v_xor_b32 v62, s76, v61
    v_lshlrev_b32_e64 v62, 4, v62
    v_lshl_add_u32 v62, v61, 8, v62
    v_lshrrev_b32_e64 v63, 3, v0
    v_lshl_add_u32 v62, v63, 1, v62
    v_add_u32 v62, 123392, v62
    v_xor_b32 v63, 16, v62
    v_and_b32 v43, 7, v0
    v_lshlrev_b32_e64 v11, 4, v43
    v_add_u32 v40, 163072, v11
    ds_read_b128 v[244:247], v40
    v_lshrrev_b32 v41, 3, v0
    s_lshl_b32 s76, s64, 3
    v_add_u32 v42, s76, v41
    v_xor_b32 v2, v43, v41
    v_lshlrev_b32 v2, 4, v2
    v_and_b32 v40, 31, v42
    v_lshl_add_u32 v2, v40, 7, v2
    v_lshrrev_b32_e64 v40, 5, v42
    v_lshl_add_u32 v2, v40, 14, v2
    v_bfe_u32 v40, v42, 1, 3
    v_xor_b32 v40, v43, v40
    v_lshlrev_b32 v40, 4, v40
    v_lshl_add_u32 v40, v42, 7, v40
    v_add_u32 v7, 123392, v40
    v_lshlrev_b32_e64 v40, 2, v42
    v_add_u32 v10, 162688, v40
    v_lshl_add_u32 v11, v42, 10, v11
    s_lshl_b32 s76, s67, 16
    s_lshl_b32 s77, s68, 7
    s_add_u32 s76, s76, s77
    v_add_u32 v11, s76, v11
    s_waitcnt lgkmcnt(0)
    v_lshlrev_b32 v240, 16, v244
    v_and_b32 v241, 0xffff0000, v244
    v_lshlrev_b32_e64 v242, 16, v245
    v_and_b32 v243, 0xffff0000, v245
    v_lshlrev_b32_e64 v244, 16, v246
    v_and_b32 v245, 0xffff0000, v246
    v_lshlrev_b32_e64 v246, 16, v247
    v_and_b32 v247, 0xffff0000, v247
    s_mov_b32 s77, 0
L_p3:

    ds_read_b128 v[56:59], v52
    s_add_u32 s77, s77, 1
    s_waitcnt lgkmcnt(0)
    v_and_b32 v56, v56, v57
    v_and_b32 v58, v58, v59
    v_and_b32 v56, v56, v58
    v_cmp_eq_u32_e64 vcc, 0, v56
    s_cmp_ge_u32 s77, 1000000
    s_cbranch_scc1 L_p3_x
    s_cbranch_vccnz L_p3
L_p3_x:
    v_add_u32_e64 v52, 48, v50
    s_mov_b32 s77, 0
L_p4:
    s_sleep 2
    ds_read_b32 v56, v52
    s_add_u32 s77, s77, 1
    s_waitcnt lgkmcnt(0)
    v_cmp_eq_u32_e64 vcc, 0, v56
    s_cmp_ge_u32 s77, 1000000
    s_cbranch_scc1 L_p4_x
    s_cbranch_vccnz L_p4
L_p4_x:
    s_waitcnt vmcnt(0)
    buffer_load_dwordx4 v[176:179], v3, s[56:59], s79 offen offset:0 sc1
    buffer_load_dwordx4 v[180:183], v3, s[56:59], s79 offen offset:1024 sc1
    s_waitcnt vmcnt(0)
    v_xor_b32 v176, v204, v176
    v_xor_b32 v180, v204, v180
    v_add_u32 v42, s22, v177
    v_add_u32 v43, s22, v178
    v_and_b32 v40, v42, v43
    v_add_u32 v44, s22, v179
    v_add_u32_e64 v45, s22, v181
    v_bitop3_b32 v40, v40, v44, v45 bitop3:0x80
    v_add_u32 v42, s22, v182
    v_add_u32 v43, s22, v183
    v_bitop3_b32 v40, v40, v42, v43 bitop3:0x80
    v_add_u32 v44, s22, v176
    v_add_u32 v45, s22, v180
    v_bitop3_b32 v40, v40, v44, v45 bitop3:0x80
    v_and_b32 v40, 0x40004000, v40
    v_cmp_ne_u32 vcc, 0x40004000, v40
    s_cbranch_vccnz L_a_slow
L_a_ok:
    s_nop 0
    ds_write_b16 v62, v176 offset:0
    ds_write_b16_d16_hi v62, v176 offset:128
    ds_write_b16 v62, v177 offset:2048
    ds_write_b16_d16_hi v62, v177 offset:2176
    ds_write_b16 v62, v178 offset:4096
    ds_write_b16_d16_hi v62, v178 offset:4224
    ds_write_b16 v62, v179 offset:6144
    ds_write_b16_d16_hi v62, v179 offset:6272
    ds_write_b16 v63, v180 offset:0
    ds_write_b16_d16_hi v63, v180 offset:128
    ds_write_b16 v63, v181 offset:2048
    ds_write_b16_d16_hi v63, v181 offset:2176
    s_waitcnt lgkmcnt(8)
    s_nop 0
    ds_write_b16 v63, v182 offset:4096
    ds_write_b16_d16_hi v63, v182 offset:4224
    ds_write_b16 v63, v183 offset:6144
    ds_write_b16_d16_hi v63, v183 offset:6272
    s_waitcnt lgkmcnt(0)
L_final:
    s_setprio 0
    s_lshl4_add_u32 s76, s65, s66
    s_lshl4_add_u32 s76, s76, s64
    s_cmp_lg_u32 s76, 0xc0
    s_mov_b32 s76, 0x3f80
    s_mov_b32 s77, 0x3f800000
    s_barrier
    ds_read_b128 v[32:35], v2 offset:32768
    ds_read_b128 v[36:39], v2 offset:36864
    ds_read_b128 v[40:43], v2 offset:40960
    ds_read_b128 v[44:47], v2 offset:45056
    ds_read_b128 v[48:51], v7
    ds_read_b32 v52, v10
    s_cbranch_scc1 L_noep
    v_mov_b32 v54, s70
    v_mov_b32 v55, s71
    v_mov_b32 v53, 0
    global_store_dwordx2 v53, v[54:55], s[42:43] sc1
L_noep:
    s_waitcnt lgkmcnt(5)
    v_dot2c_f32_bf16 v240, s76, v32
    v_dot2c_f32_bf16 v241, s77, v32
    v_dot2c_f32_bf16 v242, s76, v33
    v_dot2c_f32_bf16 v243, s77, v33
    v_dot2c_f32_bf16 v244, s76, v34
    v_dot2c_f32_bf16 v245, s77, v34
    v_dot2c_f32_bf16 v246, s76, v35
    v_dot2c_f32_bf16 v247, s77, v35
    s_waitcnt lgkmcnt(4)
    v_dot2c_f32_bf16 v240, s76, v36
    v_dot2c_f32_bf16 v241, s77, v36
    v_dot2c_f32_bf16 v242, s76, v37
    v_dot2c_f32_bf16 v243, s77, v37
    v_dot2c_f32_bf16 v244, s76, v38
    v_dot2c_f32_bf16 v245, s77, v38
    v_dot2c_f32_bf16 v246, s76, v39
    v_dot2c_f32_bf16 v247, s77, v39
    s_waitcnt lgkmcnt(3)
    v_dot2c_f32_bf16 v240, s76, v40
    v_dot2c_f32_bf16 v241, s77, v40
    v_dot2c_f32_bf16 v242, s76, v41
    v_dot2c_f32_bf16 v243, s77, v41
    v_dot2c_f32_bf16 v244, s76, v42
    v_dot2c_f32_bf16 v245, s77, v42
    v_dot2c_f32_bf16 v246, s76, v43
    v_dot2c_f32_bf16 v247, s77, v43
    s_waitcnt lgkmcnt(2)
    v_dot2c_f32_bf16 v240, s76, v44
    v_dot2c_f32_bf16 v241, s77, v44
    v_dot2c_f32_bf16 v242, s76, v45
    v_dot2c_f32_bf16 v243, s77, v45
    v_dot2c_f32_bf16 v244, s76, v46
    v_dot2c_f32_bf16 v245, s77, v46
    v_dot2c_f32_bf16 v246, s76, v47
    v_dot2c_f32_bf16 v247, s77, v47
    s_waitcnt lgkmcnt(0)
    v_lshlrev_b32 v56, 16, v48
    v_and_b32 v57, 0xffff0000, v48
    v_lshlrev_b32_e64 v58, 16, v49
    v_and_b32 v59, 0xffff0000, v49
    v_lshlrev_b32_e64 v60, 16, v50
    v_and_b32 v61, 0xffff0000, v50
    v_lshlrev_b32_e64 v62, 16, v51
    v_and_b32 v63, 0xffff0000, v51
    v_sub_f32 v56, v56, v240
    v_sub_f32 v57, v57, v241
    v_sub_f32 v58, v58, v242
    v_sub_f32 v59, v59, v243
    v_sub_f32 v60, v60, v244
    v_sub_f32 v61, v61, v245
    v_sub_f32 v62, v62, v246
    v_sub_f32 v63, v63, v247
    v_fmac_f32 v240, v52, v56
    v_fmac_f32 v241, v52, v57
    v_fmac_f32 v242, v52, v58
    v_fmac_f32 v243, v52, v59
    v_fmac_f32 v244, v52, v60
    v_fmac_f32 v245, v52, v61
    v_fmac_f32 v246, v52, v62
    v_fmac_f32 v247, v52, v63
    v_cvt_pk_bf16_f32 v12, v240, v241
    v_cvt_pk_bf16_f32 v13, v242, v243
    v_cvt_pk_bf16_f32 v14, v244, v245
    v_cvt_pk_bf16_f32 v15, v246, v247
    global_store_dwordx4 v11, v[12:15], s[38:39] nt
L_end:
    s_endpgm
L_text_end:
L_h0_slow:
    s_mov_b32 s77, 0
L_h0_loop:
    s_add_u32 s78, s99, 0
    s_nop 0
    buffer_load_dwordx4 v[160:163], v1, s[56:59], s78 offen offset:0 sc1
    buffer_load_dwordx4 v[164:167], v1, s[56:59], s78 offen offset:1024 sc1
    buffer_load_dwordx4 v[168:171], v1, s[56:59], s78 offen offset:2048 sc1
    buffer_load_dwordx4 v[172:175], v1, s[56:59], s78 offen offset:3072 sc1
    s_add_u32 s77, s77, 1

    s_waitcnt vmcnt(0)
    v_xor_b32 v160, v8, v160
    v_xor_b32 v164, v8, v164
    v_xor_b32 v168, v8, v168
    v_xor_b32 v172, v8, v172
    v_or3_b32 v12, v161, v162, v163
    v_or3_b32 v13, v165, v166, v167
    v_or3_b32 v12, v12, v169, v170
    v_or3_b32 v13, v13, v171, v173
    v_or3_b32 v12, v12, v174, v175
    v_or3_b32 v13, v13, v160, v164
    v_or3_b32 v12, v12, v168, v172
    v_bitop3_b32 v12, v12, v13, s79 bitop3:0xa8
    v_cmp_ne_u32_e64 vcc, 0, v12
    s_cmp_ge_u32 s77, 20000
    s_cbranch_scc1 L_h0_ok
    s_cbranch_vccz L_h0_re
    s_sleep 4
    s_branch L_h0_loop
L_h0_re:
    s_add_u32 s78, s99, 4096
    buffer_load_dwordx4 v[176:179], v1, s[56:59], s78 offen offset:0 sc1
    buffer_load_dwordx4 v[180:183], v1, s[56:59], s78 offen offset:1024 sc1
    buffer_load_dwordx4 v[184:187], v1, s[56:59], s78 offen offset:2048 sc1
    buffer_load_dwordx4 v[188:191], v1, s[56:59], s78 offen offset:3072 sc1
    s_add_u32 s78, s99, 8192
    buffer_load_dwordx4 v[192:195], v1, s[56:59], s78 offen offset:0 sc1
    buffer_load_dwordx4 v[196:199], v1, s[56:59], s78 offen offset:1024 sc1
    buffer_load_dwordx4 v[200:203], v1, s[56:59], s78 offen offset:2048 sc1
    buffer_load_dwordx4 v[204:207], v1, s[56:59], s78 offen offset:3072 sc1
    s_branch L_h0_ok
L_h1_slow:
    s_mov_b32 s77, 0
L_h1_loop:
    s_add_u32 s78, s99, 4096
    buffer_load_dwordx4 v[176:179], v1, s[56:59], s78 offen offset:0 sc1
    buffer_load_dwordx4 v[180:183], v1, s[56:59], s78 offen offset:1024 sc1
    buffer_load_dwordx4 v[184:187], v1, s[56:59], s78 offen offset:2048 sc1
    buffer_load_dwordx4 v[188:191], v1, s[56:59], s78 offen offset:3072 sc1
    s_add_u32 s77, s77, 1

    s_waitcnt vmcnt(0)
    v_xor_b32 v176, v8, v176
    v_xor_b32 v180, v8, v180
    v_xor_b32 v184, v8, v184
    v_xor_b32 v188, v8, v188
    v_or3_b32 v12, v177, v178, v179
    v_or3_b32 v13, v181, v182, v183
    v_or3_b32 v12, v12, v185, v186
    v_or3_b32 v13, v13, v187, v189
    v_or3_b32 v12, v12, v190, v191
    v_or3_b32 v13, v13, v176, v180
    v_or3_b32 v12, v12, v184, v188
    v_bitop3_b32 v12, v12, v13, s79 bitop3:0xa8
    v_cmp_ne_u32_e64 vcc, 0, v12
    s_cmp_ge_u32 s77, 20000
    s_cbranch_scc1 L_h1_ok
    s_cbranch_vccz L_h1_re
    s_sleep 4
    s_branch L_h1_loop
L_h1_re:
    s_add_u32 s78, s99, 8192
    buffer_load_dwordx4 v[192:195], v1, s[56:59], s78 offen offset:0 sc1
    buffer_load_dwordx4 v[196:199], v1, s[56:59], s78 offen offset:1024 sc1
    buffer_load_dwordx4 v[200:203], v1, s[56:59], s78 offen offset:2048 sc1
    buffer_load_dwordx4 v[204:207], v1, s[56:59], s78 offen offset:3072 sc1
    s_add_u32 s78, s99, 12288
    buffer_load_dwordx4 v[208:211], v1, s[56:59], s78 offen offset:0 sc1
    buffer_load_dwordx4 v[212:215], v1, s[56:59], s78 offen offset:1024 sc1
    buffer_load_dwordx4 v[216:219], v1, s[56:59], s78 offen offset:2048 sc1
    buffer_load_dwordx4 v[220:223], v1, s[56:59], s78 offen offset:3072 sc1
    s_branch L_h1_ok
L_h2_slow:
    s_mov_b32 s77, 0
L_h2_loop:
    s_add_u32 s78, s99, 8192
    buffer_load_dwordx4 v[192:195], v1, s[56:59], s78 offen offset:0 sc1
    buffer_load_dwordx4 v[196:199], v1, s[56:59], s78 offen offset:1024 sc1
    buffer_load_dwordx4 v[200:203], v1, s[56:59], s78 offen offset:2048 sc1
    buffer_load_dwordx4 v[204:207], v1, s[56:59], s78 offen offset:3072 sc1
    s_add_u32 s77, s77, 1

    s_waitcnt vmcnt(0)
    v_xor_b32 v192, v8, v192
    v_xor_b32 v196, v8, v196
    v_xor_b32 v200, v8, v200
    v_xor_b32 v204, v8, v204
    v_or3_b32 v12, v193, v194, v195
    v_or3_b32 v13, v197, v198, v199
    v_or3_b32 v12, v12, v201, v202
    v_or3_b32 v13, v13, v203, v205
    v_or3_b32 v12, v12, v206, v207
    v_or3_b32 v13, v13, v192, v196
    v_or3_b32 v12, v12, v200, v204
    v_bitop3_b32 v12, v12, v13, s79 bitop3:0xa8
    v_cmp_ne_u32_e64 vcc, 0, v12
    s_cmp_ge_u32 s77, 20000
    s_cbranch_scc1 L_h2_ok
    s_cbranch_vccz L_h2_re
    s_sleep 4
    s_branch L_h2_loop
L_h2_re:
    s_add_u32 s78, s99, 12288
    buffer_load_dwordx4 v[208:211], v1, s[56:59], s78 offen offset:0 sc1
    buffer_load_dwordx4 v[212:215], v1, s[56:59], s78 offen offset:1024 sc1
    buffer_load_dwordx4 v[216:219], v1, s[56:59], s78 offen offset:2048 sc1
    buffer_load_dwordx4 v[220:223], v1, s[56:59], s78 offen offset:3072 sc1
    s_add_u32 s78, s99, 16384
    buffer_load_dwordx4 v[224:227], v1, s[56:59], s78 offen offset:0 sc1
    buffer_load_dwordx4 v[228:231], v1, s[56:59], s78 offen offset:1024 sc1
    buffer_load_dwordx4 v[232:235], v1, s[56:59], s78 offen offset:2048 sc1
    buffer_load_dwordx4 v[236:239], v1, s[56:59], s78 offen offset:3072 sc1
    s_branch L_h2_ok
L_h3_slow:
    s_mov_b32 s77, 0
L_h3_loop:
    s_add_u32 s78, s99, 12288
    buffer_load_dwordx4 v[208:211], v1, s[56:59], s78 offen offset:0 sc1
    buffer_load_dwordx4 v[212:215], v1, s[56:59], s78 offen offset:1024 sc1
    buffer_load_dwordx4 v[216:219], v1, s[56:59], s78 offen offset:2048 sc1
    buffer_load_dwordx4 v[220:223], v1, s[56:59], s78 offen offset:3072 sc1
    s_add_u32 s77, s77, 1

    s_waitcnt vmcnt(0)
    v_xor_b32 v208, v8, v208
    v_xor_b32 v212, v8, v212
    v_xor_b32 v216, v8, v216
    v_xor_b32 v220, v8, v220
    v_or3_b32 v12, v209, v210, v211
    v_or3_b32 v13, v213, v214, v215
    v_or3_b32 v12, v12, v217, v218
    v_or3_b32 v13, v13, v219, v221
    v_or3_b32 v12, v12, v222, v223
    v_or3_b32 v13, v13, v208, v212
    v_or3_b32 v12, v12, v216, v220
    v_bitop3_b32 v12, v12, v13, s79 bitop3:0xa8
    v_cmp_ne_u32_e64 vcc, 0, v12
    s_cmp_ge_u32 s77, 20000
    s_cbranch_scc1 L_h3_ok
    s_cbranch_vccz L_h3_re
    s_sleep 4
    s_branch L_h3_loop
L_h3_re:
    s_add_u32 s78, s99, 16384
    buffer_load_dwordx4 v[224:227], v1, s[56:59], s78 offen offset:0 sc1
    buffer_load_dwordx4 v[228:231], v1, s[56:59], s78 offen offset:1024 sc1
    buffer_load_dwordx4 v[232:235], v1, s[56:59], s78 offen offset:2048 sc1
    buffer_load_dwordx4 v[236:239], v1, s[56:59], s78 offen offset:3072 sc1
    s_add_u32 s78, s99, 20480
    buffer_load_dwordx4 v[160:163], v1, s[56:59], s78 offen offset:0 sc1
    buffer_load_dwordx4 v[164:167], v1, s[56:59], s78 offen offset:1024 sc1
    buffer_load_dwordx4 v[168:171], v1, s[56:59], s78 offen offset:2048 sc1
    buffer_load_dwordx4 v[172:175], v1, s[56:59], s78 offen offset:3072 sc1
    s_branch L_h3_ok
L_h4_slow:
    s_mov_b32 s77, 0
L_h4_loop:
    s_add_u32 s78, s99, 16384
    buffer_load_dwordx4 v[224:227], v1, s[56:59], s78 offen offset:0 sc1
    buffer_load_dwordx4 v[228:231], v1, s[56:59], s78 offen offset:1024 sc1
    buffer_load_dwordx4 v[232:235], v1, s[56:59], s78 offen offset:2048 sc1
    buffer_load_dwordx4 v[236:239], v1, s[56:59], s78 offen offset:3072 sc1
    s_add_u32 s77, s77, 1

    s_waitcnt vmcnt(0)
    v_xor_b32 v224, v8, v224
    v_xor_b32 v228, v8, v228
    v_xor_b32 v232, v8, v232
    v_xor_b32 v236, v8, v236
    v_or3_b32 v12, v225, v226, v227
    v_or3_b32 v13, v229, v230, v231
    v_or3_b32 v12, v12, v233, v234
    v_or3_b32 v13, v13, v235, v237
    v_or3_b32 v12, v12, v238, v239
    v_or3_b32 v13, v13, v224, v228
    v_or3_b32 v12, v12, v232, v236
    v_bitop3_b32 v12, v12, v13, s79 bitop3:0xa8
    v_cmp_ne_u32_e64 vcc, 0, v12
    s_cmp_ge_u32 s77, 20000
    s_cbranch_scc1 L_h4_ok
    s_cbranch_vccz L_h4_re
    s_sleep 4
    s_branch L_h4_loop
L_h4_re:
    s_add_u32 s78, s99, 20480
    buffer_load_dwordx4 v[160:163], v1, s[56:59], s78 offen offset:0 sc1
    buffer_load_dwordx4 v[164:167], v1, s[56:59], s78 offen offset:1024 sc1
    buffer_load_dwordx4 v[168:171], v1, s[56:59], s78 offen offset:2048 sc1
    buffer_load_dwordx4 v[172:175], v1, s[56:59], s78 offen offset:3072 sc1
    s_add_u32 s78, s99, 24576
    buffer_load_dwordx4 v[176:179], v1, s[56:59], s78 offen offset:0 sc1
    buffer_load_dwordx4 v[180:183], v1, s[56:59], s78 offen offset:1024 sc1
    buffer_load_dwordx4 v[184:187], v1, s[56:59], s78 offen offset:2048 sc1
    buffer_load_dwordx4 v[188:191], v1, s[56:59], s78 offen offset:3072 sc1
    s_branch L_h4_ok
L_h5_slow:
    s_mov_b32 s77, 0
L_h5_loop:
    s_add_u32 s78, s99, 20480
    buffer_load_dwordx4 v[160:163], v1, s[56:59], s78 offen offset:0 sc1
    buffer_load_dwordx4 v[164:167], v1, s[56:59], s78 offen offset:1024 sc1
    buffer_load_dwordx4 v[168:171], v1, s[56:59], s78 offen offset:2048 sc1
    buffer_load_dwordx4 v[172:175], v1, s[56:59], s78 offen offset:3072 sc1
    s_add_u32 s77, s77, 1

    s_waitcnt vmcnt(0)
    v_xor_b32 v160, v8, v160
    v_xor_b32 v164, v8, v164
    v_xor_b32 v168, v8, v168
    v_xor_b32 v172, v8, v172
    v_or3_b32 v12, v161, v162, v163
    v_or3_b32 v13, v165, v166, v167
    v_or3_b32 v12, v12, v169, v170
    v_or3_b32 v13, v13, v171, v173
    v_or3_b32 v12, v12, v174, v175
    v_or3_b32 v13, v13, v160, v164
    v_or3_b32 v12, v12, v168, v172
    v_bitop3_b32 v12, v12, v13, s79 bitop3:0xa8
    v_cmp_ne_u32_e64 vcc, 0, v12
    s_cmp_ge_u32 s77, 20000
    s_cbranch_scc1 L_h5_ok
    s_cbranch_vccz L_h5_re
    s_sleep 4
    s_branch L_h5_loop
L_h5_re:
    s_add_u32 s78, s99, 24576
    buffer_load_dwordx4 v[176:179], v1, s[56:59], s78 offen offset:0 sc1
    buffer_load_dwordx4 v[180:183], v1, s[56:59], s78 offen offset:1024 sc1
    buffer_load_dwordx4 v[184:187], v1, s[56:59], s78 offen offset:2048 sc1
    buffer_load_dwordx4 v[188:191], v1, s[56:59], s78 offen offset:3072 sc1
    s_add_u32 s78, s99, 28672
    buffer_load_dwordx4 v[192:195], v1, s[56:59], s78 offen offset:0 sc1
    buffer_load_dwordx4 v[196:199], v1, s[56:59], s78 offen offset:1024 sc1
    buffer_load_dwordx4 v[200:203], v1, s[56:59], s78 offen offset:2048 sc1
    buffer_load_dwordx4 v[204:207], v1, s[56:59], s78 offen offset:3072 sc1
    s_branch L_h5_ok
L_h6_slow:
    s_mov_b32 s77, 0
L_h6_loop:
    s_add_u32 s78, s99, 24576
    buffer_load_dwordx4 v[176:179], v1, s[56:59], s78 offen offset:0 sc1
    buffer_load_dwordx4 v[180:183], v1, s[56:59], s78 offen offset:1024 sc1
    buffer_load_dwordx4 v[184:187], v1, s[56:59], s78 offen offset:2048 sc1
    buffer_load_dwordx4 v[188:191], v1, s[56:59], s78 offen offset:3072 sc1
    s_add_u32 s77, s77, 1

    s_waitcnt vmcnt(0)
    v_xor_b32 v176, v8, v176
    v_xor_b32 v180, v8, v180
    v_xor_b32 v184, v8, v184
    v_xor_b32 v188, v8, v188
    v_or3_b32 v12, v177, v178, v179
    v_or3_b32 v13, v181, v182, v183
    v_or3_b32 v12, v12, v185, v186
    v_or3_b32 v13, v13, v187, v189
    v_or3_b32 v12, v12, v190, v191
    v_or3_b32 v13, v13, v176, v180
    v_or3_b32 v12, v12, v184, v188
    v_bitop3_b32 v12, v12, v13, s79 bitop3:0xa8
    v_cmp_ne_u32_e64 vcc, 0, v12
    s_cmp_ge_u32 s77, 20000
    s_cbranch_scc1 L_h6_ok
    s_cbranch_vccz L_h6_re
    s_sleep 4
    s_branch L_h6_loop
L_h6_re:
    s_add_u32 s78, s99, 28672
    buffer_load_dwordx4 v[192:195], v1, s[56:59], s78 offen offset:0 sc1
    buffer_load_dwordx4 v[196:199], v1, s[56:59], s78 offen offset:1024 sc1
    buffer_load_dwordx4 v[200:203], v1, s[56:59], s78 offen offset:2048 sc1
    buffer_load_dwordx4 v[204:207], v1, s[56:59], s78 offen offset:3072 sc1
    s_add_u32 s78, s99, 32768
    buffer_load_dwordx4 v[208:211], v1, s[56:59], s78 offen offset:0 sc1
    buffer_load_dwordx4 v[212:215], v1, s[56:59], s78 offen offset:1024 sc1
    buffer_load_dwordx4 v[216:219], v1, s[56:59], s78 offen offset:2048 sc1
    buffer_load_dwordx4 v[220:223], v1, s[56:59], s78 offen offset:3072 sc1
    s_branch L_h6_ok
L_h7_slow:
    s_mov_b32 s77, 0
L_h7_loop:
    s_add_u32 s78, s99, 28672
    buffer_load_dwordx4 v[192:195], v1, s[56:59], s78 offen offset:0 sc1
    buffer_load_dwordx4 v[196:199], v1, s[56:59], s78 offen offset:1024 sc1
    buffer_load_dwordx4 v[200:203], v1, s[56:59], s78 offen offset:2048 sc1
    buffer_load_dwordx4 v[204:207], v1, s[56:59], s78 offen offset:3072 sc1
    s_add_u32 s77, s77, 1

    s_waitcnt vmcnt(0)
    v_xor_b32 v192, v8, v192
    v_xor_b32 v196, v8, v196
    v_xor_b32 v200, v8, v200
    v_xor_b32 v204, v8, v204
    v_or3_b32 v12, v193, v194, v195
    v_or3_b32 v13, v197, v198, v199
    v_or3_b32 v12, v12, v201, v202
    v_or3_b32 v13, v13, v203, v205
    v_or3_b32 v12, v12, v206, v207
    v_or3_b32 v13, v13, v192, v196
    v_or3_b32 v12, v12, v200, v204
    v_bitop3_b32 v12, v12, v13, s79 bitop3:0xa8
    v_cmp_ne_u32_e64 vcc, 0, v12
    s_cmp_ge_u32 s77, 20000
    s_cbranch_scc1 L_h7_ok
    s_cbranch_vccz L_h7_re
    s_sleep 4
    s_branch L_h7_loop
L_h7_re:
    s_add_u32 s78, s99, 32768
    buffer_load_dwordx4 v[208:211], v1, s[56:59], s78 offen offset:0 sc1
    buffer_load_dwordx4 v[212:215], v1, s[56:59], s78 offen offset:1024 sc1
    buffer_load_dwordx4 v[216:219], v1, s[56:59], s78 offen offset:2048 sc1
    buffer_load_dwordx4 v[220:223], v1, s[56:59], s78 offen offset:3072 sc1
    s_add_u32 s78, s99, 36864
    buffer_load_dwordx4 v[224:227], v1, s[56:59], s78 offen offset:0 sc1
    buffer_load_dwordx4 v[228:231], v1, s[56:59], s78 offen offset:1024 sc1
    buffer_load_dwordx4 v[232:235], v1, s[56:59], s78 offen offset:2048 sc1
    buffer_load_dwordx4 v[236:239], v1, s[56:59], s78 offen offset:3072 sc1
    s_branch L_h7_ok
L_h8_slow:
    s_mov_b32 s77, 0
L_h8_loop:
    s_add_u32 s78, s99, 32768
    buffer_load_dwordx4 v[208:211], v1, s[56:59], s78 offen offset:0 sc1
    buffer_load_dwordx4 v[212:215], v1, s[56:59], s78 offen offset:1024 sc1
    buffer_load_dwordx4 v[216:219], v1, s[56:59], s78 offen offset:2048 sc1
    buffer_load_dwordx4 v[220:223], v1, s[56:59], s78 offen offset:3072 sc1
    s_add_u32 s77, s77, 1

    s_waitcnt vmcnt(0)
    v_xor_b32 v208, v8, v208
    v_xor_b32 v212, v8, v212
    v_xor_b32 v216, v8, v216
    v_xor_b32 v220, v8, v220
    v_or3_b32 v12, v209, v210, v211
    v_or3_b32 v13, v213, v214, v215
    v_or3_b32 v12, v12, v217, v218
    v_or3_b32 v13, v13, v219, v221
    v_or3_b32 v12, v12, v222, v223
    v_or3_b32 v13, v13, v208, v212
    v_or3_b32 v12, v12, v216, v220
    v_bitop3_b32 v12, v12, v13, s79 bitop3:0xa8
    v_cmp_ne_u32_e64 vcc, 0, v12
    s_cmp_ge_u32 s77, 20000
    s_cbranch_scc1 L_h8_ok
    s_cbranch_vccz L_h8_re
    s_sleep 4
    s_branch L_h8_loop
L_h8_re:
    s_add_u32 s78, s99, 36864
    buffer_load_dwordx4 v[224:227], v1, s[56:59], s78 offen offset:0 sc1
    buffer_load_dwordx4 v[228:231], v1, s[56:59], s78 offen offset:1024 sc1
    buffer_load_dwordx4 v[232:235], v1, s[56:59], s78 offen offset:2048 sc1
    buffer_load_dwordx4 v[236:239], v1, s[56:59], s78 offen offset:3072 sc1
    s_add_u32 s78, s99, 40960
    buffer_load_dwordx4 v[160:163], v1, s[56:59], s78 offen offset:0 sc1
    buffer_load_dwordx4 v[164:167], v1, s[56:59], s78 offen offset:1024 sc1
    buffer_load_dwordx4 v[168:171], v1, s[56:59], s78 offen offset:2048 sc1
    buffer_load_dwordx4 v[172:175], v1, s[56:59], s78 offen offset:3072 sc1
    s_branch L_h8_ok
L_h9_slow:
    s_mov_b32 s77, 0
L_h9_loop:
    s_add_u32 s78, s99, 36864
    buffer_load_dwordx4 v[224:227], v1, s[56:59], s78 offen offset:0 sc1
    buffer_load_dwordx4 v[228:231], v1, s[56:59], s78 offen offset:1024 sc1
    buffer_load_dwordx4 v[232:235], v1, s[56:59], s78 offen offset:2048 sc1
    buffer_load_dwordx4 v[236:239], v1, s[56:59], s78 offen offset:3072 sc1
    s_add_u32 s77, s77, 1

    s_waitcnt vmcnt(0)
    v_xor_b32 v224, v8, v224
    v_xor_b32 v228, v8, v228
    v_xor_b32 v232, v8, v232
    v_xor_b32 v236, v8, v236
    v_or3_b32 v12, v225, v226, v227
    v_or3_b32 v13, v229, v230, v231
    v_or3_b32 v12, v12, v233, v234
    v_or3_b32 v13, v13, v235, v237
    v_or3_b32 v12, v12, v238, v239
    v_or3_b32 v13, v13, v224, v228
    v_or3_b32 v12, v12, v232, v236
    v_bitop3_b32 v12, v12, v13, s79 bitop3:0xa8
    v_cmp_ne_u32_e64 vcc, 0, v12
    s_cmp_ge_u32 s77, 20000
    s_cbranch_scc1 L_h9_ok
    s_cbranch_vccz L_h9_re
    s_sleep 4
    s_branch L_h9_loop
L_h9_re:
    s_add_u32 s78, s99, 40960
    buffer_load_dwordx4 v[160:163], v1, s[56:59], s78 offen offset:0 sc1
    buffer_load_dwordx4 v[164:167], v1, s[56:59], s78 offen offset:1024 sc1
    buffer_load_dwordx4 v[168:171], v1, s[56:59], s78 offen offset:2048 sc1
    buffer_load_dwordx4 v[172:175], v1, s[56:59], s78 offen offset:3072 sc1
    s_branch L_h9_ok
L_h10_slow:
    s_mov_b32 s77, 0
L_h10_loop:
    s_add_u32 s78, s99, 40960
    buffer_load_dwordx4 v[160:163], v1, s[56:59], s78 offen offset:0 sc1
    buffer_load_dwordx4 v[164:167], v1, s[56:59], s78 offen offset:1024 sc1
    buffer_load_dwordx4 v[168:171], v1, s[56:59], s78 offen offset:2048 sc1
    buffer_load_dwordx4 v[172:175], v1, s[56:59], s78 offen offset:3072 sc1
    s_add_u32 s77, s77, 1

    s_waitcnt vmcnt(0)
    v_xor_b32 v160, v8, v160
    v_xor_b32 v164, v8, v164
    v_xor_b32 v168, v8, v168
    v_xor_b32 v172, v8, v172
    v_or3_b32 v12, v161, v162, v163
    v_or3_b32 v13, v165, v166, v167
    v_or3_b32 v12, v12, v169, v170
    v_or3_b32 v13, v13, v171, v173
    v_or3_b32 v12, v12, v174, v175
    v_or3_b32 v13, v13, v160, v164
    v_or3_b32 v12, v12, v168, v172
    v_bitop3_b32 v12, v12, v13, s79 bitop3:0xa8
    v_cmp_ne_u32_e64 vcc, 0, v12
    s_cmp_ge_u32 s77, 20000
    s_cbranch_scc1 L_h10_ok
    s_cbranch_vccz L_h10_re
    s_sleep 4
    s_branch L_h10_loop
L_h10_re:

    s_branch L_h10_ok
L_u_slow:
    s_mov_b32 s77, 0
L_u_loop:
    s_sleep 2
    s_nop 0
    buffer_load_dwordx4 v[176:179], v3, s[56:59], s79 offen offset:0 sc1
    buffer_load_dwordx4 v[180:183], v3, s[56:59], s79 offen offset:1024 sc1
    buffer_load_dwordx4 v[184:187], v7, s[56:59], s78 offen sc1
    s_add_u32 s77, s77, 1

    s_waitcnt vmcnt(0)
    v_xor_b32 v176, v196, v176
    v_xor_b32 v180, v196, v180
    v_xor_b32 v184, v197, v184
    v_add_u32 v42, s22, v177
    v_add_u32 v43, s22, v178
    v_and_b32 v40, v42, v43
    v_add_u32 v44, s22, v179
    v_add_u32 v45, s22, v181
    v_bitop3_b32 v40, v40, v44, v45 bitop3:0x80
    v_add_u32 v42, s22, v182
    v_add_u32 v43, s22, v183
    v_bitop3_b32 v40, v40, v42, v43 bitop3:0x80
    v_add_u32 v44, s22, v185
    v_add_u32 v45, s22, v186
    v_bitop3_b32 v40, v40, v44, v45 bitop3:0x80
    v_add_u32 v42, s22, v187
    v_add_u32 v43, s22, v176
    v_bitop3_b32 v40, v40, v42, v43 bitop3:0x80
    v_add_u32 v44, s22, v180
    v_add_u32 v45, s22, v184
    v_bitop3_b32 v40, v40, v44, v45 bitop3:0x80
    v_and_b32 v40, 0x40004000, v40
    v_cmp_ne_u32 vcc, 0x40004000, v40
    s_cmp_ge_u32 s77, 20000
    s_cbranch_scc1 L_u_ok
    s_cbranch_vccnz L_u_loop
    s_branch L_u_ok
L_a_slow:
    s_mov_b32 s77, 0
L_a_loop:
    s_sleep 2
    buffer_load_dwordx4 v[176:179], v3, s[56:59], s79 offen offset:0 sc1
    buffer_load_dwordx4 v[180:183], v3, s[56:59], s79 offen offset:1024 sc1
    s_add_u32 s77, s77, 1

    s_waitcnt vmcnt(0)
    v_xor_b32 v176, v204, v176
    v_xor_b32 v180, v204, v180
    v_add_u32 v42, s22, v177
    v_add_u32 v43, s22, v178
    v_and_b32 v40, v42, v43
    v_add_u32 v44, s22, v179
    v_add_u32 v45, s22, v181
    v_bitop3_b32 v40, v40, v44, v45 bitop3:0x80
    v_add_u32 v42, s22, v182
    v_add_u32 v43, s22, v183
    v_bitop3_b32 v40, v40, v42, v43 bitop3:0x80
    v_add_u32 v44, s22, v176
    v_add_u32 v45, s22, v180
    v_bitop3_b32 v40, v40, v44, v45 bitop3:0x80
    v_and_b32 v40, 0x40004000, v40
    v_cmp_ne_u32 vcc, 0x40004000, v40
    s_cmp_ge_u32 s77, 20000
    s_cbranch_scc1 L_a_ok
    s_cbranch_vccnz L_a_loop
    s_branch L_a_ok
    s_endpgm
.type L_padding,@object
L_padding:
.fill (33024-(.-L_pc))/4, 4, 0
.size L_padding, .-L_padding
.section .rodata,"a"
.p2align 6

.amdhsa_kernel gated_mix__ssm_conv_s4__dense_activation_squared_relu__prompt_kernel
  .amdhsa_next_free_vgpr 256
  .amdhsa_next_free_sgpr 102
  .amdhsa_accum_offset 256
  .amdhsa_group_segment_fixed_size 0
  .amdhsa_kernarg_size 144
  .amdhsa_user_sgpr_count 2
  .amdhsa_user_sgpr_kernarg_segment_ptr 1
  .amdhsa_system_sgpr_workgroup_id_x 1
.end_amdhsa_kernel
```
